```python
import torch

def _softmax(x, axis=-1):
    return torch.softmax(x, dim=axis)
def _gelu(x):
    return torch.nn.functional.gelu(x, approximate="tanh")
def _silu(x):
    return torch.nn.functional.silu(x)
def _sigmoid(x):
    return torch.sigmoid(x)
def _layernorm(x, axis=-1, eps=1e-5):
    m = x.mean(dim=axis, keepdim=True)
    v = x.var(dim=axis, keepdim=True, unbiased=False)
    return (x - m) / torch.sqrt(v + eps)
def _scatter_add(tgt, idx, src, axis=0):
    return tgt.clone().index_add_(axis, idx, src)
def _segment_sum(src, seg, n):
    out = torch.zeros((n,) + src.shape[1:], dtype=src.dtype)
    return out.index_add_(0, seg, src)
def _pad(x, pw):
    flat = tuple(v for pair in reversed(pw) for v in pair)
    return torch.nn.functional.pad(x, flat)

kernel_name = 'standalone__gqa_softmax__near_ridge'

def setup_inputs():

    _w = (lambda a: (lambda t: t.to(torch.bfloat16) if t.is_floating_point() else t)(torch.as_tensor(a)))
    B, Hq, Hkv, Sq, Sk, D = 8, 32, 8, 48, 2048, 128
    return {
        "q": _w((lambda *s: torch.randn(*s, dtype=torch.bfloat16) * 0.8)(B, Hq, Sq, D)),
        "k": _w((lambda *s: torch.randn(*s, dtype=torch.bfloat16) * 0.8)(B, Hkv, Sk, D)),
        "v": _w((lambda *s: torch.randn(*s, dtype=torch.bfloat16) * 0.05)(B, Hkv, Sk, D)),
    }

def reference(q, k, v):
    B, Hq, Sq, D = q.shape
    Hkv = k.shape[1]
    rep = Hq // Hkv
    k = (lambda x, n, axis: torch.repeat_interleave(x, n, dim=axis))(k, rep, axis=1)
    v = (lambda x, n, axis: torch.repeat_interleave(x, n, dim=axis))(v, rep, axis=1)
    scale = D ** -0.5
    scores = torch.einsum("bhqd,bhkd->bhqk", q, k) * scale
    p = _softmax(scores, axis=-1)
    return torch.einsum("bhqk,bhkd->bhqd", p, v)
```

```asm
; @launch grid=(256,1,1) block=(256,1,1) lds=159744
.amdgcn_target "amdgcn-amd-amdhsa--gfx950"
.text
.globl standalone__gqa_softmax__near_ridge_kernel
.p2align 8
.type standalone__gqa_softmax__near_ridge_kernel,@function
standalone__gqa_softmax__near_ridge_kernel:
s_load_dwordx8 s[4:11], s[0:1], 0
s_load_dwordx4 s[12:15], s[0:1], 32
s_cmp_ge_u32 s2, 256
s_cbranch_scc1 L_end
s_mov_b32 s3, s2
v_lshrrev_b32 v232, 6, v0
v_and_b32 v240, 63, v0
s_and_b32 s42, s3, 7
v_readfirstlane_b32 s40, v232
s_lshl_b32 s42, s42, 3
s_bfe_u32 s61, s3, 0x30003
s_add_u32 s42, s42, s61
s_lshr_b32 s41, s3, 7
s_lshl_b32 s62, s42, 19
v_lshrrev_b32 v232, 4, v240
v_and_b32 v233, 15, v240
v_lshlrev_b32 v234, 1, v232
v_xor_b32 v234, v233, v234
v_lshlrev_b32 v234, 4, v234
v_lshl_add_u32 v244, v232, 8, v234
v_xor_b32 v245, 128, v244
s_and_b32 s63, s40, 1
s_lshl_b32 s64, s63, 7
v_xor_b32 v228, s64, v244
s_lshr_b32 s68, s40, 1
s_lshl_b32 s43, s40, 12
s_mul_i32 s46, s41, 229376
s_add_u32 s46, s46, s43
s_mov_b32 s47, s46
s_mul_i32 s44, s42, 49152
s_bfe_u32 s61, s3, 0x10006
s_mul_i32 s61, s61, 24576
s_add_u32 s44, s44, s61
s_mul_i32 s69, s40, 6144
s_add_u32 s67, s44, s69
s_add_u32 s64, s67, 4096
s_mul_i32 s65, s63, 12288
s_add_u32 s44, s44, s65
s_add_u32 s65, s65, 131072
s_lshl_b32 s66, s40, 10
s_mov_b32 s18, 524288
s_mov_b32 s19, 0x20000
s_mov_b32 s22, 524288
s_mov_b32 s23, 0x20000
s_mov_b32 s26, 3145728
s_mov_b32 s27, 0x20000
s_waitcnt lgkmcnt(0)
s_mov_b32 s24, s4
s_and_b32 s25, s5, 0xffff
buffer_load_dwordx4 v[0:3], v244, s[24:27], s67 offen offset:0
buffer_load_dwordx4 v[4:7], v245, s[24:27], s67 offen offset:1024
buffer_load_dwordx4 v[8:11], v244, s[24:27], s67 offen offset:2048
buffer_load_dwordx4 v[12:15], v245, s[24:27], s67 offen offset:3072
buffer_load_dwordx4 v[16:19], v244, s[24:27], s64 offen offset:0
buffer_load_dwordx4 v[20:23], v245, s[24:27], s64 offen offset:1024
s_add_u32 s16, s6, s62
s_addc_u32 s17, s7, 0
s_and_b32 s17, s17, 0xffff
s_add_u32 m0, s66, 155648
s_add_u32 s20, s8, s62
s_addc_u32 s21, s9, 0
s_and_b32 s21, s21, 0xffff
buffer_load_dwordx4 v228, s[16:19], s66 offen lds
s_add_u32 m0, s43, 0
s_nop 0
buffer_load_dwordx4 v244, s[16:19], s46 offen offset:0 nt lds
buffer_load_dwordx4 v245, s[16:19], s46 offen offset:1024 nt lds
buffer_load_dwordx4 v244, s[16:19], s46 offen offset:2048 nt lds
buffer_load_dwordx4 v245, s[16:19], s46 offen offset:3072 nt lds
s_add_u32 s46, s46, 16384
s_mov_b32 s28, s10
s_and_b32 s29, s11, 0xffff
s_mov_b32 s30, 3145728
s_mov_b32 s31, 0x20000
s_mov_b32 s32, s14
s_and_b32 s33, s15, 0xffff
s_mov_b32 s34, 0x10000000
s_mov_b32 s35, 0x20000
s_mov_b32 s36, s12
s_and_b32 s37, s13, 0xffff
s_mov_b32 s38, 256
s_mov_b32 s39, 0x20000
v_mov_b32 v242, 0
s_cmp_lt_u32 s2, 8
s_cbranch_scc0 L_nopf
s_getpc_b64 s[60:61]
v_lshlrev_b32 v236, 7, v240
s_mul_i32 s64, s40, 7424
v_min_u32 v236, 7296, v236
v_add_u32 v236, s64, v236
global_load_dword v247, v236, s[60:61] offset:512
s_or_b32 s60, s2, s40
s_cmp_lg_u32 s60, 0
s_cbranch_scc1 L_pfd
s_memrealtime s[82:83]
s_waitcnt lgkmcnt(0)
s_lshl_b32 s82, s82, 1
s_or_b32 s82, s82, 2
v_mov_b32 v238, s82
s_mov_b64 exec, 1
buffer_store_dword v238, v242, s[36:39], 0 offen sc1
s_mov_b64 exec, -1
s_branch L_pfd
L_nopf:
buffer_load_dword v247, v242, s[36:39], 0 offen offset:4092
L_pfd:
v_and_b32 v234, 7, v240
v_lshlrev_b32 v234, 1, v234
v_xor_b32 v234, v234, v232
v_lshlrev_b32 v234, 4, v234
v_lshl_add_u32 v234, v233, 8, v234
s_lshl_b32 s64, s68, 13
v_add_u32 v216, s64, v234
v_xor_b32 v217, 64, v216
v_xor_b32 v218, 128, v216
v_xor_b32 v219, 192, v216
v_add_u32 v120, s65, v234
v_add_u32 v124, 155648, v234
v_xor_b32 v121, 64, v120
v_xor_b32 v125, 64, v124
v_xor_b32 v122, 128, v120
v_xor_b32 v126, 128, v124
v_xor_b32 v123, 192, v120
v_xor_b32 v127, 192, v124
v_mov_b32 v246, v232
s_lshl_b32 s60, s40, 13
s_add_u32 s60, s60, 65536
v_and_b32 v234, 7, v240
v_lshrrev_b32 v243, 5, v240
v_xor_b32 v243, v243, v234
v_lshlrev_b32 v243, 4, v243
v_lshl_add_u32 v243, v233, 7, v243
v_bfe_u32 v233, v240, 4, 1
v_lshl_add_u32 v243, v233, 3, v243
v_add_u32 v253, s60, v243
v_lshrrev_b32 v233, 3, v240
v_xor_b32 v243, v233, v234
v_lshlrev_b32 v243, 4, v243
v_lshl_add_u32 v243, v233, 7, v243
v_add_u32 v252, s60, v243
v_lshlrev_b32 v243, 4, v234
v_lshl_add_u32 v243, v233, 8, v243
v_lshrrev_b32 v232, 2, v240
v_and_b32 v233, 7, v232
v_lshlrev_b32 v233, 5, v233
v_lshl_add_u32 v233, v232, 8, v233
v_and_b32 v232, 3, v240
v_lshl_add_u32 v233, v232, 3, v233
s_lshl_b32 s60, s68, 7
v_xor_b32 v233, s60, v233
s_add_u32 s44, s44, s60
s_add_u32 s64, s64, 65536
v_add_u32 v220, s64, v233
v_xor_b32 v221, 32, v220
v_xor_b32 v222, 64, v220
v_xor_b32 v223, 96, v220
v_xor_b32 v224, 128, v220
v_xor_b32 v225, 160, v220
v_xor_b32 v226, 192, v220
v_xor_b32 v227, 224, v220
v_lshlrev_b32 v241, 4, v240
v_lshlrev_b32 v228, 3, v240
s_lshl_b32 s60, s40, 13
v_add_u32 v251, s60, v241
v_xor_b32 v229, 16384, v251
v_mov_b32 v232, 0x3f803f80
v_mov_b32 v233, 0xbf80bf80
v_accvgpr_write_b32 a64, v232
v_accvgpr_write_b32 a68, v233
v_accvgpr_write_b32 a65, v232
v_accvgpr_write_b32 a69, v233
v_accvgpr_write_b32 a66, v232
v_accvgpr_write_b32 a70, v233
v_accvgpr_write_b32 a67, v232
v_accvgpr_write_b32 a71, v233
v_bfe_u32 v232, v240, 2, 2
v_and_b32 v234, 1, v240
v_lshlrev_b32 v234, 4, v234
v_mov_b32 v235, 0x3f80
v_lshlrev_b32 v235, v234, v235
v_cmp_eq_u32 vcc, v232, v246
v_bfe_u32 v232, v240, 1, 1
s_nop 0
v_cndmask_b32 v235, 0, v235, vcc
v_cmp_eq_u32 vcc, 0, v232
s_nop 1
v_cndmask_b32 v233, 0, v235, vcc
v_cndmask_b32 v234, v235, 0, vcc
v_accvgpr_write_b32 a72, v233
v_accvgpr_write_b32 a73, v234
v_accvgpr_write_b32 a74, 0
v_accvgpr_write_b32 a75, 0
v_accvgpr_write_b32 a76, 0
v_accvgpr_write_b32 a77, 0
v_accvgpr_write_b32 a78, v233
v_accvgpr_write_b32 a79, v234
s_mov_b32 s58, 0x3e0293ee
s_mov_b32 s59, 0x3e0293ee
s_mov_b32 s56, 0x41800000
s_mov_b32 s57, 0xc1800000
s_mov_b32 s71, 0xffff0000
s_mov_b32 s50, 0
s_mov_b32 s48, 0
s_mov_b32 s51, 4000000
s_mov_b32 s45, s41
s_and_b32 s70, s3, 127
s_lshl_b32 s70, s70, 2
s_add_u32 s70, s70, s40
s_lshl_b32 s70, s70, 13
s_add_u32 s70, s70, 0x100000
s_add_u32 s80, s70, 4096
s_cmp_eq_u32 s41, 0
s_cselect_b32 s92, 0x10000000, s70
s_cselect_b32 s94, 0, 0x80000
s_add_u32 s93, s92, 4096
s_bfe_u32 s61, s3, 0x10006
s_lshl_b32 s61, s61, 13
s_add_u32 s94, s94, s61
s_lshl_b32 s61, s40, 11
s_add_u32 s94, s94, s61
s_add_u32 s69, s69, 131072
v_add_u32 v238, s69, v241
s_waitcnt vmcnt(11)
v_lshlrev_b32 v232, 16, v0
v_and_b32 v233, s71, v0
v_pk_mul_f32 v[232:233], v[232:233], s[58:59]
v_cvt_pk_bf16_f32 v0, v232, v233
v_lshlrev_b32 v234, 16, v1
v_and_b32 v235, s71, v1
v_pk_mul_f32 v[234:235], v[234:235], s[58:59]
v_cvt_pk_bf16_f32 v1, v234, v235
v_lshlrev_b32 v232, 16, v2
v_and_b32 v233, s71, v2
v_pk_mul_f32 v[232:233], v[232:233], s[58:59]
v_cvt_pk_bf16_f32 v2, v232, v233
v_lshlrev_b32 v234, 16, v3
v_and_b32 v235, s71, v3
v_pk_mul_f32 v[234:235], v[234:235], s[58:59]
v_cvt_pk_bf16_f32 v3, v234, v235
ds_write_b128 v238, v[0:3] offset:0
s_waitcnt vmcnt(10)
v_lshlrev_b32 v232, 16, v4
v_and_b32 v233, s71, v4
v_pk_mul_f32 v[232:233], v[232:233], s[58:59]
v_cvt_pk_bf16_f32 v4, v232, v233
v_lshlrev_b32 v234, 16, v5
v_and_b32 v235, s71, v5
v_pk_mul_f32 v[234:235], v[234:235], s[58:59]
v_cvt_pk_bf16_f32 v5, v234, v235
v_lshlrev_b32 v232, 16, v6
v_and_b32 v233, s71, v6
v_pk_mul_f32 v[232:233], v[232:233], s[58:59]
v_cvt_pk_bf16_f32 v6, v232, v233
v_lshlrev_b32 v234, 16, v7
v_and_b32 v235, s71, v7
v_pk_mul_f32 v[234:235], v[234:235], s[58:59]
v_cvt_pk_bf16_f32 v7, v234, v235
ds_write_b128 v238, v[4:7] offset:1024
s_waitcnt vmcnt(9)
s_add_u32 m0, s43, 16384
s_nop 0
buffer_load_dwordx4 v244, s[16:19], s46 offen offset:0 nt lds
buffer_load_dwordx4 v245, s[16:19], s46 offen offset:1024 nt lds
buffer_load_dwordx4 v244, s[16:19], s46 offen offset:2048 nt lds
buffer_load_dwordx4 v245, s[16:19], s46 offen offset:3072 nt lds
s_add_u32 s46, s46, 16384
v_lshlrev_b32 v232, 16, v8
v_and_b32 v233, s71, v8
v_pk_mul_f32 v[232:233], v[232:233], s[58:59]
v_cvt_pk_bf16_f32 v8, v232, v233
v_lshlrev_b32 v234, 16, v9
v_and_b32 v235, s71, v9
v_pk_mul_f32 v[234:235], v[234:235], s[58:59]
v_cvt_pk_bf16_f32 v9, v234, v235
v_lshlrev_b32 v232, 16, v10
v_and_b32 v233, s71, v10
v_pk_mul_f32 v[232:233], v[232:233], s[58:59]
v_cvt_pk_bf16_f32 v10, v232, v233
v_lshlrev_b32 v234, 16, v11
v_and_b32 v235, s71, v11
v_pk_mul_f32 v[234:235], v[234:235], s[58:59]
v_cvt_pk_bf16_f32 v11, v234, v235
ds_write_b128 v238, v[8:11] offset:2048
s_waitcnt vmcnt(12)
v_lshlrev_b32 v232, 16, v12
v_and_b32 v233, s71, v12
v_pk_mul_f32 v[232:233], v[232:233], s[58:59]
v_cvt_pk_bf16_f32 v12, v232, v233
v_lshlrev_b32 v234, 16, v13
v_and_b32 v235, s71, v13
v_pk_mul_f32 v[234:235], v[234:235], s[58:59]
v_cvt_pk_bf16_f32 v13, v234, v235
v_lshlrev_b32 v232, 16, v14
v_and_b32 v233, s71, v14
v_pk_mul_f32 v[232:233], v[232:233], s[58:59]
v_cvt_pk_bf16_f32 v14, v232, v233
v_lshlrev_b32 v234, 16, v15
v_and_b32 v235, s71, v15
v_pk_mul_f32 v[234:235], v[234:235], s[58:59]
v_cvt_pk_bf16_f32 v15, v234, v235
ds_write_b128 v238, v[12:15] offset:3072
s_waitcnt vmcnt(11)
v_lshlrev_b32 v232, 16, v16
v_and_b32 v233, s71, v16
v_pk_mul_f32 v[232:233], v[232:233], s[58:59]
v_cvt_pk_bf16_f32 v16, v232, v233
v_lshlrev_b32 v234, 16, v17
v_and_b32 v235, s71, v17
v_pk_mul_f32 v[234:235], v[234:235], s[58:59]
v_cvt_pk_bf16_f32 v17, v234, v235
v_lshlrev_b32 v232, 16, v18
v_and_b32 v233, s71, v18
v_pk_mul_f32 v[232:233], v[232:233], s[58:59]
v_cvt_pk_bf16_f32 v18, v232, v233
v_lshlrev_b32 v234, 16, v19
v_and_b32 v235, s71, v19
v_pk_mul_f32 v[234:235], v[234:235], s[58:59]
v_cvt_pk_bf16_f32 v19, v234, v235
ds_write_b128 v238, v[16:19] offset:4096
s_waitcnt vmcnt(10)
s_add_u32 m0, s43, 65536
s_nop 0
buffer_load_dwordx4 v244, s[20:23], s47 offen offset:0 nt lds
buffer_load_dwordx4 v245, s[20:23], s47 offen offset:1024 nt lds
buffer_load_dwordx4 v244, s[20:23], s47 offen offset:2048 nt lds
buffer_load_dwordx4 v245, s[20:23], s47 offen offset:3072 nt lds
s_add_u32 s47, s47, 16384
v_lshlrev_b32 v232, 16, v20
v_and_b32 v233, s71, v20
v_pk_mul_f32 v[232:233], v[232:233], s[58:59]
v_cvt_pk_bf16_f32 v20, v232, v233
v_lshlrev_b32 v234, 16, v21
v_and_b32 v235, s71, v21
v_pk_mul_f32 v[234:235], v[234:235], s[58:59]
v_cvt_pk_bf16_f32 v21, v234, v235
v_lshlrev_b32 v232, 16, v22
v_and_b32 v233, s71, v22
v_pk_mul_f32 v[232:233], v[232:233], s[58:59]
v_cvt_pk_bf16_f32 v22, v232, v233
v_lshlrev_b32 v234, 16, v23
v_and_b32 v235, s71, v23
v_pk_mul_f32 v[234:235], v[234:235], s[58:59]
v_cvt_pk_bf16_f32 v23, v234, v235
ds_write_b128 v238, v[20:23] offset:5120
s_waitcnt vmcnt(13) lgkmcnt(0)
s_barrier
ds_read_b128 a[32:35], v124
ds_read_b128 a[36:39], v125
ds_read_b128 a[40:43], v126
ds_read_b128 a[44:47], v127
ds_read_b128 a[80:83], v120 offset:0
ds_read_b128 a[84:87], v121 offset:0
ds_read_b128 a[88:91], v122 offset:0
ds_read_b128 a[92:95], v123 offset:0
ds_read_b128 a[96:99], v120 offset:4096
ds_read_b128 a[100:103], v121 offset:4096
ds_read_b128 a[104:107], v122 offset:4096
ds_read_b128 a[108:111], v123 offset:4096
s_waitcnt lgkmcnt(4)
ds_read_b128 a[112:115], v120 offset:8192
ds_read_b128 a[116:119], v121 offset:8192
ds_read_b128 a[120:123], v122 offset:8192
ds_read_b128 a[124:127], v123 offset:8192
v_mfma_f32_16x16x32_bf16 v[156:159], a[32:35], a[80:83], 0
v_mfma_f32_16x16x32_bf16 v[156:159], a[36:39], a[84:87], v[156:159]
v_mfma_f32_16x16x32_bf16 v[156:159], a[40:43], a[88:91], v[156:159]
v_mfma_f32_16x16x32_bf16 v[156:159], a[44:47], a[92:95], v[156:159]
s_waitcnt lgkmcnt(4)
v_mfma_f32_16x16x32_bf16 v[160:163], a[32:35], a[96:99], 0
v_mfma_f32_16x16x32_bf16 v[160:163], a[36:39], a[100:103], v[160:163]
v_mfma_f32_16x16x32_bf16 v[160:163], a[40:43], a[104:107], v[160:163]
v_mfma_f32_16x16x32_bf16 v[160:163], a[44:47], a[108:111], v[160:163]
s_waitcnt lgkmcnt(0)
v_mfma_f32_16x16x32_bf16 v[164:167], a[32:35], a[112:115], 0
v_mfma_f32_16x16x32_bf16 v[164:167], a[36:39], a[116:119], v[164:167]
v_mfma_f32_16x16x32_bf16 v[164:167], a[40:43], a[120:123], v[164:167]
v_mfma_f32_16x16x32_bf16 v[164:167], a[44:47], a[124:127], v[164:167]
s_waitcnt vmcnt(9)
s_barrier
ds_read_b128 a[128:131], v216 offset:0
ds_read_b128 a[132:135], v217 offset:0
ds_read_b128 a[136:139], v218 offset:0
ds_read_b128 a[140:143], v219 offset:0
ds_read_b128 a[144:147], v216 offset:4096
ds_read_b128 a[148:151], v217 offset:4096
ds_read_b128 a[152:155], v218 offset:4096
ds_read_b128 a[156:159], v219 offset:4096
s_add_u32 m0, s43, 32768
s_nop 0
buffer_load_dwordx4 v244, s[16:19], s46 offen offset:0 nt lds
buffer_load_dwordx4 v245, s[16:19], s46 offen offset:1024 nt lds
buffer_load_dwordx4 v244, s[16:19], s46 offen offset:2048 nt lds
buffer_load_dwordx4 v245, s[16:19], s46 offen offset:3072 nt lds
s_add_u32 s46, s46, 16384
v_max3_f32 v232, v156, v157, v158
v_max_f32 v232, v232, v159
v_mov_b32 v233, v232
s_nop 1
v_permlane16_swap_b32 v232, v233
v_max_f32 v232, v232, v233
v_mov_b32 v233, v232
s_nop 1
v_permlane32_swap_b32 v232, v233
v_max_f32 v232, v232, v233
v_sub_f32 v156, s57, v232
v_sub_f32 v157, s57, v232
v_sub_f32 v158, s57, v232
v_sub_f32 v159, s57, v232
v_sub_f32 v248, s57, v232
s_waitcnt lgkmcnt(0)
v_mfma_f32_16x16x32_bf16 v[96:99], a[128:131], a[80:83], v[156:159]
v_max3_f32 v234, v160, v161, v162
v_max_f32 v234, v234, v163
v_mfma_f32_16x16x32_bf16 v[96:99], a[132:135], a[84:87], v[96:99]
v_mov_b32 v235, v234
s_nop 1
v_permlane16_swap_b32 v234, v235
v_mfma_f32_16x16x32_bf16 v[96:99], a[136:139], a[88:91], v[96:99]
v_max_f32 v234, v234, v235
v_mov_b32 v235, v234
v_mfma_f32_16x16x32_bf16 v[96:99], a[140:143], a[92:95], v[96:99]
s_nop 0
v_permlane32_swap_b32 v234, v235
v_max_f32 v234, v234, v235
v_mfma_f32_16x16x32_bf16 v[100:103], a[144:147], a[80:83], v[156:159]
v_sub_f32 v160, s57, v234
v_sub_f32 v161, s57, v234
v_mfma_f32_16x16x32_bf16 v[100:103], a[148:151], a[84:87], v[100:103]
v_sub_f32 v162, s57, v234
v_sub_f32 v163, s57, v234
v_mfma_f32_16x16x32_bf16 v[100:103], a[152:155], a[88:91], v[100:103]
v_sub_f32 v249, s57, v234
v_mfma_f32_16x16x32_bf16 v[100:103], a[156:159], a[92:95], v[100:103]
v_mfma_f32_16x16x32_bf16 v[104:107], a[128:131], a[96:99], v[160:163]
v_max3_f32 v236, v164, v165, v166
v_max_f32 v236, v236, v167
v_mfma_f32_16x16x32_bf16 v[104:107], a[132:135], a[100:103], v[104:107]
v_mov_b32 v237, v236
s_nop 1
v_permlane16_swap_b32 v236, v237
v_mfma_f32_16x16x32_bf16 v[104:107], a[136:139], a[104:107], v[104:107]
v_max_f32 v236, v236, v237
v_mov_b32 v237, v236
v_mfma_f32_16x16x32_bf16 v[104:107], a[140:143], a[108:111], v[104:107]
s_nop 0
v_permlane32_swap_b32 v236, v237
v_max_f32 v236, v236, v237
v_mfma_f32_16x16x32_bf16 v[108:111], a[144:147], a[96:99], v[160:163]
v_sub_f32 v164, s57, v236
v_sub_f32 v165, s57, v236
v_mfma_f32_16x16x32_bf16 v[108:111], a[148:151], a[100:103], v[108:111]
v_sub_f32 v166, s57, v236
v_sub_f32 v167, s57, v236
v_mfma_f32_16x16x32_bf16 v[108:111], a[152:155], a[104:107], v[108:111]
v_sub_f32 v250, s57, v236
v_mfma_f32_16x16x32_bf16 v[108:111], a[156:159], a[108:111], v[108:111]
s_waitcnt vmcnt(8)
s_barrier
ds_read_b128 a[0:3], v216 offset:16384
ds_read_b128 a[4:7], v217 offset:16384
ds_read_b128 a[8:11], v218 offset:16384
ds_read_b128 a[12:15], v219 offset:16384
ds_read_b128 a[16:19], v216 offset:20480
ds_read_b128 a[20:23], v217 offset:20480
ds_read_b128 a[24:27], v218 offset:20480
ds_read_b128 a[28:31], v219 offset:20480
v_mfma_f32_16x16x32_bf16 v[112:115], a[128:131], a[112:115], v[164:167]
v_exp_f32 v168, v96 clamp
v_mfma_f32_16x16x32_bf16 v[112:115], a[132:135], a[116:119], v[112:115]
v_exp_f32 v169, v97 clamp
v_mfma_f32_16x16x32_bf16 v[112:115], a[136:139], a[120:123], v[112:115]
v_exp_f32 v170, v98 clamp
v_mfma_f32_16x16x32_bf16 v[112:115], a[140:143], a[124:127], v[112:115]
v_exp_f32 v171, v99 clamp
v_mfma_f32_16x16x32_bf16 v[116:119], a[144:147], a[112:115], v[164:167]
v_exp_f32 v172, v100 clamp
v_mfma_f32_16x16x32_bf16 v[116:119], a[148:151], a[116:119], v[116:119]
v_exp_f32 v173, v101 clamp
v_mfma_f32_16x16x32_bf16 v[116:119], a[152:155], a[120:123], v[116:119]
v_exp_f32 v174, v102 clamp
v_mfma_f32_16x16x32_bf16 v[116:119], a[156:159], a[124:127], v[116:119]
v_exp_f32 v175, v103 clamp
v_cvt_pk_bf16_f32 v144, v168, v169
v_cvt_pk_bf16_f32 v145, v170, v171
v_cvt_pk_bf16_f32 v146, v172, v173
v_cvt_pk_bf16_f32 v147, v174, v175
s_waitcnt lgkmcnt(0)
L_main:
s_cmp_lg_u32 s41, 0
s_cbranch_scc0 L_firstA
v_mfma_f32_16x16x32_bf16 v[120:123], a[0:3], a[80:83], v[156:159]
s_waitcnt vmcnt(4)
s_barrier
v_exp_f32 v168, v104 clamp
v_mfma_f32_16x16x32_bf16 v[120:123], a[4:7], a[84:87], v[120:123]
ds_read_b64_tr_b16 a[32:33], v220 offset:0
ds_read_b64_tr_b16 a[34:35], v220 offset:4096
v_mfma_f32_16x16x32_bf16 v[120:123], a[8:11], a[88:91], v[120:123]
s_add_u32 m0, s43, 49152
v_exp_f32 v169, v105 clamp
v_mfma_f32_16x16x32_bf16 v[176:179], a[64:67], v[144:147], 0
buffer_load_dwordx4 v244, s[16:19], s46 offen offset:0 nt lds
ds_read_b64_tr_b16 a[36:37], v221 offset:0
v_cvt_pk_bf16_f32 v148, v168, v169
v_mfma_f32_16x16x32_bf16 v[120:123], a[12:15], a[92:95], v[120:123]
v_mfma_f32_16x16x32_bf16 v[124:127], a[16:19], a[80:83], v[156:159]
v_exp_f32 v170, v106 clamp
v_mfma_f32_16x16x32_bf16 v[124:127], a[20:23], a[84:87], v[124:127]
s_waitcnt lgkmcnt(3)
ds_read_b64_tr_b16 a[38:39], v221 offset:4096
ds_read_b64_tr_b16 a[40:41], v222 offset:0
v_mfma_f32_16x16x32_bf16 v[124:127], a[24:27], a[88:91], v[124:127]
buffer_load_dwordx4 v245, s[16:19], s46 offen offset:1024 nt lds
v_exp_f32 v171, v107 clamp
v_mfma_f32_16x16x32_bf16 v[124:127], a[28:31], a[92:95], v[124:127]
ds_read_b64_tr_b16 a[42:43], v222 offset:4096
v_cvt_pk_bf16_f32 v149, v170, v171
v_mfma_f32_16x16x32_bf16 v[128:131], a[0:3], a[96:99], v[160:163]
v_exp_f32 v172, v108 clamp
v_mfma_f32_16x16x32_bf16 v[128:131], a[4:7], a[100:103], v[128:131]
v_mfma_f32_16x16x32_bf16 v[128:131], a[8:11], a[104:107], v[128:131]
buffer_load_dwordx4 v244, s[16:19], s46 offen offset:2048 nt lds
ds_read_b64_tr_b16 a[44:45], v223 offset:0
ds_read_b64_tr_b16 a[46:47], v223 offset:4096
v_mfma_f32_16x16x32_bf16 v[128:131], a[12:15], a[108:111], v[128:131]
v_exp_f32 v173, v109 clamp
v_mfma_f32_16x16x32_bf16 v[132:135], a[16:19], a[96:99], v[160:163]
ds_read_b64_tr_b16 a[48:49], v224 offset:0
v_cvt_pk_bf16_f32 v150, v172, v173
v_mfma_f32_16x16x32_bf16 v[132:135], a[20:23], a[100:103], v[132:135]
v_exp_f32 v174, v110 clamp
v_mfma_f32_16x16x32_bf16 v[132:135], a[24:27], a[104:107], v[132:135]
buffer_load_dwordx4 v245, s[16:19], s46 offen offset:3072 nt lds
s_add_u32 s46, s46, 16384
ds_read_b64_tr_b16 a[50:51], v224 offset:4096
ds_read_b64_tr_b16 a[52:53], v225 offset:0
v_mfma_f32_16x16x32_bf16 v[132:135], a[28:31], a[108:111], v[132:135]
v_cmp_ngt_f32 vcc, 1.0, v176
v_mfma_f32_16x16x32_bf16 v[136:139], a[0:3], a[112:115], v[164:167]
v_exp_f32 v175, v111 clamp
v_mfma_f32_16x16x32_bf16 v[136:139], a[4:7], a[116:119], v[136:139]
s_cbranch_vccnz L_rs_s0_0
L_rs_s0_0_ret:
s_add_u32 m0, s43, 81920
ds_read_b64_tr_b16 a[54:55], v225 offset:4096
ds_read_b64_tr_b16 a[56:57], v226 offset:0
v_mfma_f32_16x16x32_bf16 v[136:139], a[8:11], a[120:123], v[136:139]
buffer_load_dwordx4 v244, s[20:23], s47 offen offset:0 nt lds
ds_read_b64_tr_b16 a[58:59], v226 offset:4096
v_cvt_pk_bf16_f32 v151, v174, v175
v_mfma_f32_16x16x32_bf16 v[136:139], a[12:15], a[124:127], v[136:139]
ds_read_b64_tr_b16 a[60:61], v227 offset:0
ds_read_b64_tr_b16 a[62:63], v227 offset:4096
v_mfma_f32_16x16x32_bf16 v[140:143], a[16:19], a[112:115], v[164:167]
v_exp_f32 v168, v112 clamp
v_mfma_f32_16x16x32_bf16 v[140:143], a[20:23], a[116:119], v[140:143]
v_mfma_f32_16x16x32_bf16 v[180:183], a[64:67], v[148:151], 0
buffer_load_dwordx4 v245, s[20:23], s47 offen offset:1024 nt lds
v_exp_f32 v169, v113 clamp
v_mfma_f32_16x16x32_bf16 v[140:143], a[24:27], a[120:123], v[140:143]
s_waitcnt lgkmcnt(0)
v_exp_f32 v170, v114 clamp
v_mfma_f32_16x16x32_bf16 v[140:143], a[28:31], a[124:127], v[140:143]
s_waitcnt vmcnt(6)
s_barrier
v_exp_f32 v171, v115 clamp
v_mfma_f32_16x16x32_bf16 v[0:3], a[32:35], v[144:147], 0
ds_read_b128 a[0:3], v216 offset:32768
v_cvt_pk_bf16_f32 v152, v168, v169
v_mfma_f32_16x16x32_bf16 v[12:15], a[36:39], v[144:147], 0
buffer_load_dwordx4 v244, s[20:23], s47 offen offset:2048 nt lds
v_exp_f32 v172, v116 clamp
v_mfma_f32_16x16x32_bf16 v[24:27], a[40:43], v[144:147], 0
v_cmp_ngt_f32 vcc, 1.0, v180
v_mfma_f32_16x16x32_bf16 v[36:39], a[44:47], v[144:147], 0
ds_read_b128 a[4:7], v217 offset:32768
v_cvt_pk_bf16_f32 v153, v170, v171
v_mfma_f32_16x16x32_bf16 v[48:51], a[48:51], v[144:147], 0
s_cbranch_vccnz L_rs_s0_1
L_rs_s0_1_ret:
v_exp_f32 v173, v117 clamp
v_mfma_f32_16x16x32_bf16 v[60:63], a[52:55], v[144:147], 0
buffer_load_dwordx4 v245, s[20:23], s47 offen offset:3072 nt lds
s_add_u32 s47, s47, 16384
v_exp_f32 v174, v118 clamp
v_mfma_f32_16x16x32_bf16 v[72:75], a[56:59], v[144:147], 0
s_add_u32 m0, s43, 0
ds_read_b128 a[8:11], v218 offset:32768
v_cvt_pk_bf16_f32 v154, v172, v173
v_mfma_f32_16x16x32_bf16 v[84:87], a[60:63], v[144:147], 0
buffer_load_dwordx4 v244, s[16:19], s46 offen offset:0 nt lds
v_exp_f32 v175, v119 clamp
v_mfma_f32_16x16x32_bf16 v[4:7], a[32:35], v[148:151], 0
buffer_load_dwordx4 v245, s[16:19], s46 offen offset:1024 nt lds
v_mfma_f32_16x16x32_bf16 v[16:19], a[36:39], v[148:151], 0
buffer_load_dwordx4 v244, s[16:19], s46 offen offset:2048 nt lds
ds_read_b128 a[12:15], v219 offset:32768
v_cvt_pk_bf16_f32 v155, v174, v175
v_mfma_f32_16x16x32_bf16 v[28:31], a[40:43], v[148:151], 0
buffer_load_dwordx4 v245, s[16:19], s46 offen offset:3072 nt lds
s_add_u32 s46, s46, 16384
v_exp_f32 v168, v120 clamp
v_mfma_f32_16x16x32_bf16 v[184:187], a[64:67], v[152:155], 0
s_add_u32 m0, s43, 98304
v_exp_f32 v169, v121 clamp
v_mfma_f32_16x16x32_bf16 v[40:43], a[44:47], v[148:151], 0
buffer_load_dwordx4 v244, s[20:23], s47 offen offset:0 nt lds
ds_read_b128 a[16:19], v216 offset:36864
v_cvt_pk_bf16_f32 v144, v168, v169
v_mfma_f32_16x16x32_bf16 v[52:55], a[48:51], v[148:151], 0
buffer_load_dwordx4 v245, s[20:23], s47 offen offset:1024 nt lds
v_exp_f32 v170, v122 clamp
v_mfma_f32_16x16x32_bf16 v[64:67], a[52:55], v[148:151], 0
buffer_load_dwordx4 v244, s[20:23], s47 offen offset:2048 nt lds
v_mfma_f32_16x16x32_bf16 v[76:79], a[56:59], v[148:151], 0
v_exp_f32 v171, v123 clamp
v_cmp_ngt_f32 vcc, 1.0, v184
v_mfma_f32_16x16x32_bf16 v[88:91], a[60:63], v[148:151], 0
s_cbranch_vccnz L_rs_s0_2
L_rs_s0_2_ret:
ds_read_b128 a[20:23], v217 offset:36864
v_cvt_pk_bf16_f32 v145, v170, v171
v_mfma_f32_16x16x32_bf16 v[8:11], a[32:35], v[152:155], 0
v_exp_f32 v172, v124 clamp
v_mfma_f32_16x16x32_bf16 v[20:23], a[36:39], v[152:155], 0
v_exp_f32 v173, v125 clamp
v_mfma_f32_16x16x32_bf16 v[32:35], a[40:43], v[152:155], 0
ds_read_b128 a[24:27], v218 offset:36864
v_cvt_pk_bf16_f32 v146, v172, v173
v_mfma_f32_16x16x32_bf16 v[44:47], a[44:47], v[152:155], 0
buffer_load_dwordx4 v245, s[20:23], s47 offen offset:3072 nt lds
s_add_u32 s47, s47, 16384
v_mfma_f32_16x16x32_bf16 v[56:59], a[48:51], v[152:155], 0
ds_read_b128 a[28:31], v219 offset:36864
v_mfma_f32_16x16x32_bf16 v[68:71], a[52:55], v[152:155], 0
v_exp_f32 v174, v126 clamp
v_mfma_f32_16x16x32_bf16 v[80:83], a[56:59], v[152:155], 0
v_exp_f32 v175, v127 clamp
v_mfma_f32_16x16x32_bf16 v[92:95], a[60:63], v[152:155], 0
s_waitcnt lgkmcnt(1)
v_cvt_pk_bf16_f32 v147, v174, v175
v_mfma_f32_16x16x32_bf16 v[96:99], a[0:3], a[80:83], v[156:159]
s_waitcnt vmcnt(8)
s_barrier
v_exp_f32 v168, v128 clamp
v_mfma_f32_16x16x32_bf16 v[96:99], a[4:7], a[84:87], v[96:99]
ds_read_b64_tr_b16 a[32:33], v220 offset:16384
ds_read_b64_tr_b16 a[34:35], v220 offset:20480
v_mfma_f32_16x16x32_bf16 v[96:99], a[8:11], a[88:91], v[96:99]
v_exp_f32 v169, v129 clamp
v_mfma_f32_16x16x32_bf16 v[176:179], a[64:67], v[144:147], v[176:179]
s_add_u32 m0, s43, 16384
ds_read_b64_tr_b16 a[36:37], v221 offset:16384
v_cvt_pk_bf16_f32 v148, v168, v169
v_mfma_f32_16x16x32_bf16 v[96:99], a[12:15], a[92:95], v[96:99]
buffer_load_dwordx4 v244, s[16:19], s46 offen offset:0 nt lds
v_mfma_f32_16x16x32_bf16 v[100:103], a[16:19], a[80:83], v[156:159]
v_exp_f32 v170, v130 clamp
v_mfma_f32_16x16x32_bf16 v[100:103], a[20:23], a[84:87], v[100:103]
s_waitcnt lgkmcnt(3)
ds_read_b64_tr_b16 a[38:39], v221 offset:20480
ds_read_b64_tr_b16 a[40:41], v222 offset:16384
v_mfma_f32_16x16x32_bf16 v[100:103], a[24:27], a[88:91], v[100:103]
v_exp_f32 v171, v131 clamp
v_mfma_f32_16x16x32_bf16 v[100:103], a[28:31], a[92:95], v[100:103]
ds_read_b64_tr_b16 a[42:43], v222 offset:20480
v_cvt_pk_bf16_f32 v149, v170, v171
v_mfma_f32_16x16x32_bf16 v[104:107], a[0:3], a[96:99], v[160:163]
v_exp_f32 v172, v132 clamp
v_mfma_f32_16x16x32_bf16 v[104:107], a[4:7], a[100:103], v[104:107]
buffer_load_dwordx4 v245, s[16:19], s46 offen offset:1024 nt lds
v_mfma_f32_16x16x32_bf16 v[104:107], a[8:11], a[104:107], v[104:107]
ds_read_b64_tr_b16 a[44:45], v223 offset:16384
ds_read_b64_tr_b16 a[46:47], v223 offset:20480
v_mfma_f32_16x16x32_bf16 v[104:107], a[12:15], a[108:111], v[104:107]
v_exp_f32 v173, v133 clamp
v_mfma_f32_16x16x32_bf16 v[108:111], a[16:19], a[96:99], v[160:163]
ds_read_b64_tr_b16 a[48:49], v224 offset:16384
v_cvt_pk_bf16_f32 v150, v172, v173
v_mfma_f32_16x16x32_bf16 v[108:111], a[20:23], a[100:103], v[108:111]
v_exp_f32 v174, v134 clamp
v_mfma_f32_16x16x32_bf16 v[108:111], a[24:27], a[104:107], v[108:111]
ds_read_b64_tr_b16 a[50:51], v224 offset:20480
ds_read_b64_tr_b16 a[52:53], v225 offset:16384
v_mfma_f32_16x16x32_bf16 v[108:111], a[28:31], a[108:111], v[108:111]
buffer_load_dwordx4 v244, s[16:19], s46 offen offset:2048 nt lds
v_cmp_ngt_f32 vcc, 1.0, v176
v_mfma_f32_16x16x32_bf16 v[112:115], a[0:3], a[112:115], v[164:167]
v_exp_f32 v175, v135 clamp
v_mfma_f32_16x16x32_bf16 v[112:115], a[4:7], a[116:119], v[112:115]
s_cbranch_vccnz L_rs_s1_0
L_rs_s1_0_ret:
ds_read_b64_tr_b16 a[54:55], v225 offset:20480
ds_read_b64_tr_b16 a[56:57], v226 offset:16384
v_mfma_f32_16x16x32_bf16 v[112:115], a[8:11], a[120:123], v[112:115]
ds_read_b64_tr_b16 a[58:59], v226 offset:20480
v_cvt_pk_bf16_f32 v151, v174, v175
v_mfma_f32_16x16x32_bf16 v[112:115], a[12:15], a[124:127], v[112:115]
ds_read_b64_tr_b16 a[60:61], v227 offset:16384
ds_read_b64_tr_b16 a[62:63], v227 offset:20480
v_mfma_f32_16x16x32_bf16 v[116:119], a[16:19], a[112:115], v[164:167]
v_exp_f32 v168, v136 clamp
v_mfma_f32_16x16x32_bf16 v[116:119], a[20:23], a[116:119], v[116:119]
buffer_load_dwordx4 v245, s[16:19], s46 offen offset:3072 nt lds
s_add_u32 s46, s46, 16384
v_mfma_f32_16x16x32_bf16 v[180:183], a[64:67], v[148:151], v[180:183]
v_exp_f32 v169, v137 clamp
v_mfma_f32_16x16x32_bf16 v[116:119], a[24:27], a[120:123], v[116:119]
s_waitcnt lgkmcnt(0)
v_exp_f32 v170, v138 clamp
v_mfma_f32_16x16x32_bf16 v[116:119], a[28:31], a[124:127], v[116:119]
v_exp_f32 v171, v139 clamp
v_mfma_f32_16x16x32_bf16 v[0:3], a[32:35], v[144:147], v[0:3]
ds_read_b128 a[0:3], v216 offset:49152
v_cvt_pk_bf16_f32 v152, v168, v169
v_mfma_f32_16x16x32_bf16 v[12:15], a[36:39], v[144:147], v[12:15]
s_add_u32 m0, s43, 114688
v_exp_f32 v172, v140 clamp
v_mfma_f32_16x16x32_bf16 v[24:27], a[40:43], v[144:147], v[24:27]
buffer_load_dwordx4 v244, s[20:23], s47 offen offset:0 nt lds
v_cmp_ngt_f32 vcc, 1.0, v180
v_mfma_f32_16x16x32_bf16 v[36:39], a[44:47], v[144:147], v[36:39]
ds_read_b128 a[4:7], v217 offset:49152
v_cvt_pk_bf16_f32 v153, v170, v171
v_mfma_f32_16x16x32_bf16 v[48:51], a[48:51], v[144:147], v[48:51]
s_cbranch_vccnz L_rs_s1_1
L_rs_s1_1_ret:
v_exp_f32 v173, v141 clamp
v_mfma_f32_16x16x32_bf16 v[60:63], a[52:55], v[144:147], v[60:63]
v_exp_f32 v174, v142 clamp
v_mfma_f32_16x16x32_bf16 v[72:75], a[56:59], v[144:147], v[72:75]
ds_read_b128 a[8:11], v218 offset:49152
v_cvt_pk_bf16_f32 v154, v172, v173
v_mfma_f32_16x16x32_bf16 v[84:87], a[60:63], v[144:147], v[84:87]
v_exp_f32 v175, v143 clamp
v_mfma_f32_16x16x32_bf16 v[4:7], a[32:35], v[148:151], v[4:7]
buffer_load_dwordx4 v245, s[20:23], s47 offen offset:1024 nt lds
v_mfma_f32_16x16x32_bf16 v[16:19], a[36:39], v[148:151], v[16:19]
ds_read_b128 a[12:15], v219 offset:49152
v_cvt_pk_bf16_f32 v155, v174, v175
v_mfma_f32_16x16x32_bf16 v[28:31], a[40:43], v[148:151], v[28:31]
v_exp_f32 v168, v96 clamp
v_mfma_f32_16x16x32_bf16 v[184:187], a[64:67], v[152:155], v[184:187]
v_exp_f32 v169, v97 clamp
v_mfma_f32_16x16x32_bf16 v[40:43], a[44:47], v[148:151], v[40:43]
ds_read_b128 a[16:19], v216 offset:53248
v_cvt_pk_bf16_f32 v144, v168, v169
v_mfma_f32_16x16x32_bf16 v[52:55], a[48:51], v[148:151], v[52:55]
v_exp_f32 v170, v98 clamp
v_mfma_f32_16x16x32_bf16 v[64:67], a[52:55], v[148:151], v[64:67]
buffer_load_dwordx4 v244, s[20:23], s47 offen offset:2048 nt lds
v_mfma_f32_16x16x32_bf16 v[76:79], a[56:59], v[148:151], v[76:79]
v_exp_f32 v171, v99 clamp
v_cmp_ngt_f32 vcc, 1.0, v184
v_mfma_f32_16x16x32_bf16 v[88:91], a[60:63], v[148:151], v[88:91]
s_cbranch_vccnz L_rs_s1_2
L_rs_s1_2_ret:
ds_read_b128 a[20:23], v217 offset:53248
v_cvt_pk_bf16_f32 v145, v170, v171
v_mfma_f32_16x16x32_bf16 v[8:11], a[32:35], v[152:155], v[8:11]
v_exp_f32 v172, v100 clamp
v_mfma_f32_16x16x32_bf16 v[20:23], a[36:39], v[152:155], v[20:23]
v_exp_f32 v173, v101 clamp
v_mfma_f32_16x16x32_bf16 v[32:35], a[40:43], v[152:155], v[32:35]
ds_read_b128 a[24:27], v218 offset:53248
v_cvt_pk_bf16_f32 v146, v172, v173
v_mfma_f32_16x16x32_bf16 v[44:47], a[44:47], v[152:155], v[44:47]
buffer_load_dwordx4 v245, s[20:23], s47 offen offset:3072 nt lds
s_add_u32 s47, s47, 16384
v_mfma_f32_16x16x32_bf16 v[56:59], a[48:51], v[152:155], v[56:59]
ds_read_b128 a[28:31], v219 offset:53248
v_mfma_f32_16x16x32_bf16 v[68:71], a[52:55], v[152:155], v[68:71]
v_exp_f32 v174, v102 clamp
v_mfma_f32_16x16x32_bf16 v[80:83], a[56:59], v[152:155], v[80:83]
v_exp_f32 v175, v103 clamp
v_mfma_f32_16x16x32_bf16 v[92:95], a[60:63], v[152:155], v[92:95]
s_waitcnt lgkmcnt(1)
v_cvt_pk_bf16_f32 v147, v174, v175
v_mfma_f32_16x16x32_bf16 v[120:123], a[0:3], a[80:83], v[156:159]
s_waitcnt vmcnt(8)
s_barrier
v_exp_f32 v168, v104 clamp
v_mfma_f32_16x16x32_bf16 v[120:123], a[4:7], a[84:87], v[120:123]
ds_read_b64_tr_b16 a[32:33], v220 offset:32768
ds_read_b64_tr_b16 a[34:35], v220 offset:36864
v_mfma_f32_16x16x32_bf16 v[120:123], a[8:11], a[88:91], v[120:123]
v_exp_f32 v169, v105 clamp
v_mfma_f32_16x16x32_bf16 v[176:179], a[64:67], v[144:147], v[176:179]
s_add_u32 m0, s43, 32768
ds_read_b64_tr_b16 a[36:37], v221 offset:32768
v_cvt_pk_bf16_f32 v148, v168, v169
v_mfma_f32_16x16x32_bf16 v[120:123], a[12:15], a[92:95], v[120:123]
buffer_load_dwordx4 v244, s[16:19], s46 offen offset:0 nt lds
v_mfma_f32_16x16x32_bf16 v[124:127], a[16:19], a[80:83], v[156:159]
v_exp_f32 v170, v106 clamp
v_mfma_f32_16x16x32_bf16 v[124:127], a[20:23], a[84:87], v[124:127]
s_waitcnt lgkmcnt(3)
ds_read_b64_tr_b16 a[38:39], v221 offset:36864
ds_read_b64_tr_b16 a[40:41], v222 offset:32768
v_mfma_f32_16x16x32_bf16 v[124:127], a[24:27], a[88:91], v[124:127]
v_exp_f32 v171, v107 clamp
v_mfma_f32_16x16x32_bf16 v[124:127], a[28:31], a[92:95], v[124:127]
ds_read_b64_tr_b16 a[42:43], v222 offset:36864
v_cvt_pk_bf16_f32 v149, v170, v171
v_mfma_f32_16x16x32_bf16 v[128:131], a[0:3], a[96:99], v[160:163]
v_exp_f32 v172, v108 clamp
v_mfma_f32_16x16x32_bf16 v[128:131], a[4:7], a[100:103], v[128:131]
buffer_load_dwordx4 v245, s[16:19], s46 offen offset:1024 nt lds
v_mfma_f32_16x16x32_bf16 v[128:131], a[8:11], a[104:107], v[128:131]
ds_read_b64_tr_b16 a[44:45], v223 offset:32768
ds_read_b64_tr_b16 a[46:47], v223 offset:36864
v_mfma_f32_16x16x32_bf16 v[128:131], a[12:15], a[108:111], v[128:131]
v_exp_f32 v173, v109 clamp
v_mfma_f32_16x16x32_bf16 v[132:135], a[16:19], a[96:99], v[160:163]
ds_read_b64_tr_b16 a[48:49], v224 offset:32768
v_cvt_pk_bf16_f32 v150, v172, v173
v_mfma_f32_16x16x32_bf16 v[132:135], a[20:23], a[100:103], v[132:135]
v_exp_f32 v174, v110 clamp
v_mfma_f32_16x16x32_bf16 v[132:135], a[24:27], a[104:107], v[132:135]
ds_read_b64_tr_b16 a[50:51], v224 offset:36864
ds_read_b64_tr_b16 a[52:53], v225 offset:32768
v_mfma_f32_16x16x32_bf16 v[132:135], a[28:31], a[108:111], v[132:135]
buffer_load_dwordx4 v244, s[16:19], s46 offen offset:2048 nt lds
v_cmp_ngt_f32 vcc, 1.0, v176
v_mfma_f32_16x16x32_bf16 v[136:139], a[0:3], a[112:115], v[164:167]
v_exp_f32 v175, v111 clamp
v_mfma_f32_16x16x32_bf16 v[136:139], a[4:7], a[116:119], v[136:139]
s_cbranch_vccnz L_rs_s2_0
L_rs_s2_0_ret:
ds_read_b64_tr_b16 a[54:55], v225 offset:36864
ds_read_b64_tr_b16 a[56:57], v226 offset:32768
v_mfma_f32_16x16x32_bf16 v[136:139], a[8:11], a[120:123], v[136:139]
ds_read_b64_tr_b16 a[58:59], v226 offset:36864
v_cvt_pk_bf16_f32 v151, v174, v175
v_mfma_f32_16x16x32_bf16 v[136:139], a[12:15], a[124:127], v[136:139]
ds_read_b64_tr_b16 a[60:61], v227 offset:32768
ds_read_b64_tr_b16 a[62:63], v227 offset:36864
v_mfma_f32_16x16x32_bf16 v[140:143], a[16:19], a[112:115], v[164:167]
v_exp_f32 v168, v112 clamp
v_mfma_f32_16x16x32_bf16 v[140:143], a[20:23], a[116:119], v[140:143]
buffer_load_dwordx4 v245, s[16:19], s46 offen offset:3072 nt lds
s_add_u32 s46, s46, 16384
v_mfma_f32_16x16x32_bf16 v[180:183], a[64:67], v[148:151], v[180:183]
v_exp_f32 v169, v113 clamp
v_mfma_f32_16x16x32_bf16 v[140:143], a[24:27], a[120:123], v[140:143]
s_waitcnt lgkmcnt(0)
v_exp_f32 v170, v114 clamp
v_mfma_f32_16x16x32_bf16 v[140:143], a[28:31], a[124:127], v[140:143]
v_exp_f32 v171, v115 clamp
v_mfma_f32_16x16x32_bf16 v[0:3], a[32:35], v[144:147], v[0:3]
ds_read_b128 a[0:3], v216 offset:0
v_cvt_pk_bf16_f32 v152, v168, v169
v_mfma_f32_16x16x32_bf16 v[12:15], a[36:39], v[144:147], v[12:15]
s_add_u32 m0, s43, 65536
v_exp_f32 v172, v116 clamp
v_mfma_f32_16x16x32_bf16 v[24:27], a[40:43], v[144:147], v[24:27]
buffer_load_dwordx4 v244, s[20:23], s47 offen offset:0 nt lds
v_cmp_ngt_f32 vcc, 1.0, v180
v_mfma_f32_16x16x32_bf16 v[36:39], a[44:47], v[144:147], v[36:39]
ds_read_b128 a[4:7], v217 offset:0
v_cvt_pk_bf16_f32 v153, v170, v171
v_mfma_f32_16x16x32_bf16 v[48:51], a[48:51], v[144:147], v[48:51]
s_cbranch_vccnz L_rs_s2_1
L_rs_s2_1_ret:
v_exp_f32 v173, v117 clamp
v_mfma_f32_16x16x32_bf16 v[60:63], a[52:55], v[144:147], v[60:63]
v_exp_f32 v174, v118 clamp
v_mfma_f32_16x16x32_bf16 v[72:75], a[56:59], v[144:147], v[72:75]
ds_read_b128 a[8:11], v218 offset:0
v_cvt_pk_bf16_f32 v154, v172, v173
v_mfma_f32_16x16x32_bf16 v[84:87], a[60:63], v[144:147], v[84:87]
v_exp_f32 v175, v119 clamp
v_mfma_f32_16x16x32_bf16 v[4:7], a[32:35], v[148:151], v[4:7]
buffer_load_dwordx4 v245, s[20:23], s47 offen offset:1024 nt lds
v_mfma_f32_16x16x32_bf16 v[16:19], a[36:39], v[148:151], v[16:19]
ds_read_b128 a[12:15], v219 offset:0
v_cvt_pk_bf16_f32 v155, v174, v175
v_mfma_f32_16x16x32_bf16 v[28:31], a[40:43], v[148:151], v[28:31]
v_exp_f32 v168, v120 clamp
v_mfma_f32_16x16x32_bf16 v[184:187], a[64:67], v[152:155], v[184:187]
v_exp_f32 v169, v121 clamp
v_mfma_f32_16x16x32_bf16 v[40:43], a[44:47], v[148:151], v[40:43]
ds_read_b128 a[16:19], v216 offset:4096
v_cvt_pk_bf16_f32 v144, v168, v169
v_mfma_f32_16x16x32_bf16 v[52:55], a[48:51], v[148:151], v[52:55]
v_exp_f32 v170, v122 clamp
v_mfma_f32_16x16x32_bf16 v[64:67], a[52:55], v[148:151], v[64:67]
buffer_load_dwordx4 v244, s[20:23], s47 offen offset:2048 nt lds
v_mfma_f32_16x16x32_bf16 v[76:79], a[56:59], v[148:151], v[76:79]
v_exp_f32 v171, v123 clamp
v_cmp_ngt_f32 vcc, 1.0, v184
v_mfma_f32_16x16x32_bf16 v[88:91], a[60:63], v[148:151], v[88:91]
s_cbranch_vccnz L_rs_s2_2
L_rs_s2_2_ret:
ds_read_b128 a[20:23], v217 offset:4096
v_cvt_pk_bf16_f32 v145, v170, v171
v_mfma_f32_16x16x32_bf16 v[8:11], a[32:35], v[152:155], v[8:11]
v_exp_f32 v172, v124 clamp
v_mfma_f32_16x16x32_bf16 v[20:23], a[36:39], v[152:155], v[20:23]
v_exp_f32 v173, v125 clamp
v_mfma_f32_16x16x32_bf16 v[32:35], a[40:43], v[152:155], v[32:35]
ds_read_b128 a[24:27], v218 offset:4096
v_cvt_pk_bf16_f32 v146, v172, v173
v_mfma_f32_16x16x32_bf16 v[44:47], a[44:47], v[152:155], v[44:47]
buffer_load_dwordx4 v245, s[20:23], s47 offen offset:3072 nt lds
s_add_u32 s47, s47, 16384
v_mfma_f32_16x16x32_bf16 v[56:59], a[48:51], v[152:155], v[56:59]
ds_read_b128 a[28:31], v219 offset:4096
v_mfma_f32_16x16x32_bf16 v[68:71], a[52:55], v[152:155], v[68:71]
v_exp_f32 v174, v126 clamp
v_mfma_f32_16x16x32_bf16 v[80:83], a[56:59], v[152:155], v[80:83]
v_exp_f32 v175, v127 clamp
v_mfma_f32_16x16x32_bf16 v[92:95], a[60:63], v[152:155], v[92:95]
s_waitcnt lgkmcnt(1)
v_cvt_pk_bf16_f32 v147, v174, v175
v_mfma_f32_16x16x32_bf16 v[96:99], a[0:3], a[80:83], v[156:159]
s_waitcnt vmcnt(8)
s_barrier
v_exp_f32 v168, v128 clamp
v_mfma_f32_16x16x32_bf16 v[96:99], a[4:7], a[84:87], v[96:99]
ds_read_b64_tr_b16 a[32:33], v220 offset:49152
ds_read_b64_tr_b16 a[34:35], v220 offset:53248
v_mfma_f32_16x16x32_bf16 v[96:99], a[8:11], a[88:91], v[96:99]
v_exp_f32 v169, v129 clamp
v_mfma_f32_16x16x32_bf16 v[176:179], a[64:67], v[144:147], v[176:179]
s_add_u32 m0, s43, 49152
ds_read_b64_tr_b16 a[36:37], v221 offset:49152
v_cvt_pk_bf16_f32 v148, v168, v169
v_mfma_f32_16x16x32_bf16 v[96:99], a[12:15], a[92:95], v[96:99]
buffer_load_dwordx4 v244, s[16:19], s46 offen offset:0 nt lds
v_mfma_f32_16x16x32_bf16 v[100:103], a[16:19], a[80:83], v[156:159]
v_exp_f32 v170, v130 clamp
v_mfma_f32_16x16x32_bf16 v[100:103], a[20:23], a[84:87], v[100:103]
s_waitcnt lgkmcnt(3)
ds_read_b64_tr_b16 a[38:39], v221 offset:53248
ds_read_b64_tr_b16 a[40:41], v222 offset:49152
v_mfma_f32_16x16x32_bf16 v[100:103], a[24:27], a[88:91], v[100:103]
v_exp_f32 v171, v131 clamp
v_mfma_f32_16x16x32_bf16 v[100:103], a[28:31], a[92:95], v[100:103]
ds_read_b64_tr_b16 a[42:43], v222 offset:53248
v_cvt_pk_bf16_f32 v149, v170, v171
v_mfma_f32_16x16x32_bf16 v[104:107], a[0:3], a[96:99], v[160:163]
v_exp_f32 v172, v132 clamp
v_mfma_f32_16x16x32_bf16 v[104:107], a[4:7], a[100:103], v[104:107]
buffer_load_dwordx4 v245, s[16:19], s46 offen offset:1024 nt lds
v_mfma_f32_16x16x32_bf16 v[104:107], a[8:11], a[104:107], v[104:107]
ds_read_b64_tr_b16 a[44:45], v223 offset:49152
ds_read_b64_tr_b16 a[46:47], v223 offset:53248
v_mfma_f32_16x16x32_bf16 v[104:107], a[12:15], a[108:111], v[104:107]
v_exp_f32 v173, v133 clamp
v_mfma_f32_16x16x32_bf16 v[108:111], a[16:19], a[96:99], v[160:163]
ds_read_b64_tr_b16 a[48:49], v224 offset:49152
v_cvt_pk_bf16_f32 v150, v172, v173
v_mfma_f32_16x16x32_bf16 v[108:111], a[20:23], a[100:103], v[108:111]
v_exp_f32 v174, v134 clamp
v_mfma_f32_16x16x32_bf16 v[108:111], a[24:27], a[104:107], v[108:111]
ds_read_b64_tr_b16 a[50:51], v224 offset:53248
ds_read_b64_tr_b16 a[52:53], v225 offset:49152
v_mfma_f32_16x16x32_bf16 v[108:111], a[28:31], a[108:111], v[108:111]
buffer_load_dwordx4 v244, s[16:19], s46 offen offset:2048 nt lds
v_cmp_ngt_f32 vcc, 1.0, v176
v_mfma_f32_16x16x32_bf16 v[112:115], a[0:3], a[112:115], v[164:167]
v_exp_f32 v175, v135 clamp
v_mfma_f32_16x16x32_bf16 v[112:115], a[4:7], a[116:119], v[112:115]
s_cbranch_vccnz L_rs_s3_0
L_rs_s3_0_ret:
ds_read_b64_tr_b16 a[54:55], v225 offset:53248
ds_read_b64_tr_b16 a[56:57], v226 offset:49152
v_mfma_f32_16x16x32_bf16 v[112:115], a[8:11], a[120:123], v[112:115]
ds_read_b64_tr_b16 a[58:59], v226 offset:53248
v_cvt_pk_bf16_f32 v151, v174, v175
v_mfma_f32_16x16x32_bf16 v[112:115], a[12:15], a[124:127], v[112:115]
ds_read_b64_tr_b16 a[60:61], v227 offset:49152
ds_read_b64_tr_b16 a[62:63], v227 offset:53248
v_mfma_f32_16x16x32_bf16 v[116:119], a[16:19], a[112:115], v[164:167]
v_exp_f32 v168, v136 clamp
v_mfma_f32_16x16x32_bf16 v[116:119], a[20:23], a[116:119], v[116:119]
buffer_load_dwordx4 v245, s[16:19], s46 offen offset:3072 nt lds
s_add_u32 s46, s46, 16384
v_mfma_f32_16x16x32_bf16 v[180:183], a[64:67], v[148:151], v[180:183]
v_exp_f32 v169, v137 clamp
v_mfma_f32_16x16x32_bf16 v[116:119], a[24:27], a[120:123], v[116:119]
s_waitcnt lgkmcnt(0)
v_exp_f32 v170, v138 clamp
v_mfma_f32_16x16x32_bf16 v[116:119], a[28:31], a[124:127], v[116:119]
v_exp_f32 v171, v139 clamp
v_mfma_f32_16x16x32_bf16 v[0:3], a[32:35], v[144:147], v[0:3]
ds_read_b128 a[0:3], v216 offset:16384
v_cvt_pk_bf16_f32 v152, v168, v169
v_mfma_f32_16x16x32_bf16 v[12:15], a[36:39], v[144:147], v[12:15]
s_add_u32 m0, s43, 81920
v_exp_f32 v172, v140 clamp
v_mfma_f32_16x16x32_bf16 v[24:27], a[40:43], v[144:147], v[24:27]
buffer_load_dwordx4 v244, s[20:23], s47 offen offset:0 nt lds
v_cmp_ngt_f32 vcc, 1.0, v180
v_mfma_f32_16x16x32_bf16 v[36:39], a[44:47], v[144:147], v[36:39]
ds_read_b128 a[4:7], v217 offset:16384
v_cvt_pk_bf16_f32 v153, v170, v171
v_mfma_f32_16x16x32_bf16 v[48:51], a[48:51], v[144:147], v[48:51]
s_cbranch_vccnz L_rs_s3_1
L_rs_s3_1_ret:
v_exp_f32 v173, v141 clamp
v_mfma_f32_16x16x32_bf16 v[60:63], a[52:55], v[144:147], v[60:63]
v_exp_f32 v174, v142 clamp
v_mfma_f32_16x16x32_bf16 v[72:75], a[56:59], v[144:147], v[72:75]
ds_read_b128 a[8:11], v218 offset:16384
v_cvt_pk_bf16_f32 v154, v172, v173
v_mfma_f32_16x16x32_bf16 v[84:87], a[60:63], v[144:147], v[84:87]
v_exp_f32 v175, v143 clamp
v_mfma_f32_16x16x32_bf16 v[4:7], a[32:35], v[148:151], v[4:7]
buffer_load_dwordx4 v245, s[20:23], s47 offen offset:1024 nt lds
v_mfma_f32_16x16x32_bf16 v[16:19], a[36:39], v[148:151], v[16:19]
ds_read_b128 a[12:15], v219 offset:16384
v_cvt_pk_bf16_f32 v155, v174, v175
v_mfma_f32_16x16x32_bf16 v[28:31], a[40:43], v[148:151], v[28:31]
v_exp_f32 v168, v96 clamp
v_mfma_f32_16x16x32_bf16 v[184:187], a[64:67], v[152:155], v[184:187]
v_exp_f32 v169, v97 clamp
v_mfma_f32_16x16x32_bf16 v[40:43], a[44:47], v[148:151], v[40:43]
ds_read_b128 a[16:19], v216 offset:20480
v_cvt_pk_bf16_f32 v144, v168, v169
v_mfma_f32_16x16x32_bf16 v[52:55], a[48:51], v[148:151], v[52:55]
v_exp_f32 v170, v98 clamp
v_mfma_f32_16x16x32_bf16 v[64:67], a[52:55], v[148:151], v[64:67]
buffer_load_dwordx4 v244, s[20:23], s47 offen offset:2048 nt lds
v_mfma_f32_16x16x32_bf16 v[76:79], a[56:59], v[148:151], v[76:79]
v_exp_f32 v171, v99 clamp
v_cmp_ngt_f32 vcc, 1.0, v184
v_mfma_f32_16x16x32_bf16 v[88:91], a[60:63], v[148:151], v[88:91]
s_cbranch_vccnz L_rs_s3_2
L_rs_s3_2_ret:
ds_read_b128 a[20:23], v217 offset:20480
v_cvt_pk_bf16_f32 v145, v170, v171
v_mfma_f32_16x16x32_bf16 v[8:11], a[32:35], v[152:155], v[8:11]
v_exp_f32 v172, v100 clamp
v_mfma_f32_16x16x32_bf16 v[20:23], a[36:39], v[152:155], v[20:23]
v_exp_f32 v173, v101 clamp
v_mfma_f32_16x16x32_bf16 v[32:35], a[40:43], v[152:155], v[32:35]
ds_read_b128 a[24:27], v218 offset:20480
v_cvt_pk_bf16_f32 v146, v172, v173
v_mfma_f32_16x16x32_bf16 v[44:47], a[44:47], v[152:155], v[44:47]
buffer_load_dwordx4 v245, s[20:23], s47 offen offset:3072 nt lds
s_add_u32 s47, s47, 16384
v_mfma_f32_16x16x32_bf16 v[56:59], a[48:51], v[152:155], v[56:59]
ds_read_b128 a[28:31], v219 offset:20480
v_mfma_f32_16x16x32_bf16 v[68:71], a[52:55], v[152:155], v[68:71]
v_exp_f32 v174, v102 clamp
v_mfma_f32_16x16x32_bf16 v[80:83], a[56:59], v[152:155], v[80:83]
v_exp_f32 v175, v103 clamp
v_mfma_f32_16x16x32_bf16 v[92:95], a[60:63], v[152:155], v[92:95]
s_waitcnt lgkmcnt(1)
v_cvt_pk_bf16_f32 v147, v174, v175
v_mfma_f32_16x16x32_bf16 v[120:123], a[0:3], a[80:83], v[156:159]
s_waitcnt vmcnt(8)
s_barrier
v_exp_f32 v168, v104 clamp
v_mfma_f32_16x16x32_bf16 v[120:123], a[4:7], a[84:87], v[120:123]
ds_read_b64_tr_b16 a[32:33], v220 offset:0
ds_read_b64_tr_b16 a[34:35], v220 offset:4096
v_mfma_f32_16x16x32_bf16 v[120:123], a[8:11], a[88:91], v[120:123]
v_exp_f32 v169, v105 clamp
v_mfma_f32_16x16x32_bf16 v[176:179], a[64:67], v[144:147], v[176:179]
s_add_u32 m0, s43, 0
ds_read_b64_tr_b16 a[36:37], v221 offset:0
v_cvt_pk_bf16_f32 v148, v168, v169
v_mfma_f32_16x16x32_bf16 v[120:123], a[12:15], a[92:95], v[120:123]
buffer_load_dwordx4 v244, s[16:19], s46 offen offset:0 nt lds
v_mfma_f32_16x16x32_bf16 v[124:127], a[16:19], a[80:83], v[156:159]
v_exp_f32 v170, v106 clamp
v_mfma_f32_16x16x32_bf16 v[124:127], a[20:23], a[84:87], v[124:127]
s_waitcnt lgkmcnt(3)
ds_read_b64_tr_b16 a[38:39], v221 offset:4096
ds_read_b64_tr_b16 a[40:41], v222 offset:0
v_mfma_f32_16x16x32_bf16 v[124:127], a[24:27], a[88:91], v[124:127]
v_exp_f32 v171, v107 clamp
v_mfma_f32_16x16x32_bf16 v[124:127], a[28:31], a[92:95], v[124:127]
ds_read_b64_tr_b16 a[42:43], v222 offset:4096
v_cvt_pk_bf16_f32 v149, v170, v171
v_mfma_f32_16x16x32_bf16 v[128:131], a[0:3], a[96:99], v[160:163]
v_exp_f32 v172, v108 clamp
v_mfma_f32_16x16x32_bf16 v[128:131], a[4:7], a[100:103], v[128:131]
buffer_load_dwordx4 v245, s[16:19], s46 offen offset:1024 nt lds
v_mfma_f32_16x16x32_bf16 v[128:131], a[8:11], a[104:107], v[128:131]
ds_read_b64_tr_b16 a[44:45], v223 offset:0
ds_read_b64_tr_b16 a[46:47], v223 offset:4096
v_mfma_f32_16x16x32_bf16 v[128:131], a[12:15], a[108:111], v[128:131]
v_exp_f32 v173, v109 clamp
v_mfma_f32_16x16x32_bf16 v[132:135], a[16:19], a[96:99], v[160:163]
ds_read_b64_tr_b16 a[48:49], v224 offset:0
v_cvt_pk_bf16_f32 v150, v172, v173
v_mfma_f32_16x16x32_bf16 v[132:135], a[20:23], a[100:103], v[132:135]
v_exp_f32 v174, v110 clamp
v_mfma_f32_16x16x32_bf16 v[132:135], a[24:27], a[104:107], v[132:135]
ds_read_b64_tr_b16 a[50:51], v224 offset:4096
ds_read_b64_tr_b16 a[52:53], v225 offset:0
v_mfma_f32_16x16x32_bf16 v[132:135], a[28:31], a[108:111], v[132:135]
buffer_load_dwordx4 v244, s[16:19], s46 offen offset:2048 nt lds
v_cmp_ngt_f32 vcc, 1.0, v176
v_mfma_f32_16x16x32_bf16 v[136:139], a[0:3], a[112:115], v[164:167]
v_exp_f32 v175, v111 clamp
v_mfma_f32_16x16x32_bf16 v[136:139], a[4:7], a[116:119], v[136:139]
s_cbranch_vccnz L_rs_s4_0
L_rs_s4_0_ret:
ds_read_b64_tr_b16 a[54:55], v225 offset:4096
ds_read_b64_tr_b16 a[56:57], v226 offset:0
v_mfma_f32_16x16x32_bf16 v[136:139], a[8:11], a[120:123], v[136:139]
ds_read_b64_tr_b16 a[58:59], v226 offset:4096
v_cvt_pk_bf16_f32 v151, v174, v175
v_mfma_f32_16x16x32_bf16 v[136:139], a[12:15], a[124:127], v[136:139]
ds_read_b64_tr_b16 a[60:61], v227 offset:0
ds_read_b64_tr_b16 a[62:63], v227 offset:4096
v_mfma_f32_16x16x32_bf16 v[140:143], a[16:19], a[112:115], v[164:167]
v_exp_f32 v168, v112 clamp
v_mfma_f32_16x16x32_bf16 v[140:143], a[20:23], a[116:119], v[140:143]
buffer_load_dwordx4 v245, s[16:19], s46 offen offset:3072 nt lds
s_add_u32 s46, s46, 16384
v_mfma_f32_16x16x32_bf16 v[180:183], a[64:67], v[148:151], v[180:183]
v_exp_f32 v169, v113 clamp
v_mfma_f32_16x16x32_bf16 v[140:143], a[24:27], a[120:123], v[140:143]
s_waitcnt lgkmcnt(0)
v_exp_f32 v170, v114 clamp
v_mfma_f32_16x16x32_bf16 v[140:143], a[28:31], a[124:127], v[140:143]
v_exp_f32 v171, v115 clamp
v_mfma_f32_16x16x32_bf16 v[0:3], a[32:35], v[144:147], v[0:3]
ds_read_b128 a[0:3], v216 offset:32768
v_cvt_pk_bf16_f32 v152, v168, v169
v_mfma_f32_16x16x32_bf16 v[12:15], a[36:39], v[144:147], v[12:15]
s_add_u32 m0, s43, 98304
v_exp_f32 v172, v116 clamp
v_mfma_f32_16x16x32_bf16 v[24:27], a[40:43], v[144:147], v[24:27]
buffer_load_dwordx4 v244, s[20:23], s47 offen offset:0 nt lds
v_cmp_ngt_f32 vcc, 1.0, v180
v_mfma_f32_16x16x32_bf16 v[36:39], a[44:47], v[144:147], v[36:39]
ds_read_b128 a[4:7], v217 offset:32768
v_cvt_pk_bf16_f32 v153, v170, v171
v_mfma_f32_16x16x32_bf16 v[48:51], a[48:51], v[144:147], v[48:51]
s_cbranch_vccnz L_rs_s4_1
L_rs_s4_1_ret:
v_exp_f32 v173, v117 clamp
v_mfma_f32_16x16x32_bf16 v[60:63], a[52:55], v[144:147], v[60:63]
v_exp_f32 v174, v118 clamp
v_mfma_f32_16x16x32_bf16 v[72:75], a[56:59], v[144:147], v[72:75]
ds_read_b128 a[8:11], v218 offset:32768
v_cvt_pk_bf16_f32 v154, v172, v173
v_mfma_f32_16x16x32_bf16 v[84:87], a[60:63], v[144:147], v[84:87]
v_exp_f32 v175, v119 clamp
v_mfma_f32_16x16x32_bf16 v[4:7], a[32:35], v[148:151], v[4:7]
buffer_load_dwordx4 v245, s[20:23], s47 offen offset:1024 nt lds
v_mfma_f32_16x16x32_bf16 v[16:19], a[36:39], v[148:151], v[16:19]
ds_read_b128 a[12:15], v219 offset:32768
v_cvt_pk_bf16_f32 v155, v174, v175
v_mfma_f32_16x16x32_bf16 v[28:31], a[40:43], v[148:151], v[28:31]
v_exp_f32 v168, v120 clamp
v_mfma_f32_16x16x32_bf16 v[184:187], a[64:67], v[152:155], v[184:187]
v_exp_f32 v169, v121 clamp
v_mfma_f32_16x16x32_bf16 v[40:43], a[44:47], v[148:151], v[40:43]
ds_read_b128 a[16:19], v216 offset:36864
v_cvt_pk_bf16_f32 v144, v168, v169
v_mfma_f32_16x16x32_bf16 v[52:55], a[48:51], v[148:151], v[52:55]
v_exp_f32 v170, v122 clamp
v_mfma_f32_16x16x32_bf16 v[64:67], a[52:55], v[148:151], v[64:67]
buffer_load_dwordx4 v244, s[20:23], s47 offen offset:2048 nt lds
v_mfma_f32_16x16x32_bf16 v[76:79], a[56:59], v[148:151], v[76:79]
v_exp_f32 v171, v123 clamp
v_cmp_ngt_f32 vcc, 1.0, v184
v_mfma_f32_16x16x32_bf16 v[88:91], a[60:63], v[148:151], v[88:91]
s_cbranch_vccnz L_rs_s4_2
L_rs_s4_2_ret:
ds_read_b128 a[20:23], v217 offset:36864
v_cvt_pk_bf16_f32 v145, v170, v171
v_mfma_f32_16x16x32_bf16 v[8:11], a[32:35], v[152:155], v[8:11]
v_exp_f32 v172, v124 clamp
v_mfma_f32_16x16x32_bf16 v[20:23], a[36:39], v[152:155], v[20:23]
v_exp_f32 v173, v125 clamp
v_mfma_f32_16x16x32_bf16 v[32:35], a[40:43], v[152:155], v[32:35]
ds_read_b128 a[24:27], v218 offset:36864
v_cvt_pk_bf16_f32 v146, v172, v173
v_mfma_f32_16x16x32_bf16 v[44:47], a[44:47], v[152:155], v[44:47]
buffer_load_dwordx4 v245, s[20:23], s47 offen offset:3072 nt lds
s_add_u32 s47, s47, 16384
v_mfma_f32_16x16x32_bf16 v[56:59], a[48:51], v[152:155], v[56:59]
ds_read_b128 a[28:31], v219 offset:36864
v_mfma_f32_16x16x32_bf16 v[68:71], a[52:55], v[152:155], v[68:71]
v_exp_f32 v174, v126 clamp
v_mfma_f32_16x16x32_bf16 v[80:83], a[56:59], v[152:155], v[80:83]
v_exp_f32 v175, v127 clamp
v_mfma_f32_16x16x32_bf16 v[92:95], a[60:63], v[152:155], v[92:95]
s_waitcnt lgkmcnt(1)
v_cvt_pk_bf16_f32 v147, v174, v175
L_join:
v_mfma_f32_16x16x32_bf16 v[96:99], a[0:3], a[80:83], v[156:159]
s_waitcnt vmcnt(8)
s_barrier
v_exp_f32 v168, v128 clamp
v_mfma_f32_16x16x32_bf16 v[96:99], a[4:7], a[84:87], v[96:99]
ds_read_b64_tr_b16 a[32:33], v220 offset:16384
ds_read_b64_tr_b16 a[34:35], v220 offset:20480
v_mfma_f32_16x16x32_bf16 v[96:99], a[8:11], a[88:91], v[96:99]
v_exp_f32 v169, v129 clamp
v_mfma_f32_16x16x32_bf16 v[176:179], a[64:67], v[144:147], v[176:179]
s_add_u32 m0, s43, 16384
ds_read_b64_tr_b16 a[36:37], v221 offset:16384
v_cvt_pk_bf16_f32 v148, v168, v169
v_mfma_f32_16x16x32_bf16 v[96:99], a[12:15], a[92:95], v[96:99]
buffer_load_dwordx4 v244, s[16:19], s46 offen offset:0 nt lds
v_mfma_f32_16x16x32_bf16 v[100:103], a[16:19], a[80:83], v[156:159]
v_exp_f32 v170, v130 clamp
v_mfma_f32_16x16x32_bf16 v[100:103], a[20:23], a[84:87], v[100:103]
s_waitcnt lgkmcnt(3)
ds_read_b64_tr_b16 a[38:39], v221 offset:20480
ds_read_b64_tr_b16 a[40:41], v222 offset:16384
v_mfma_f32_16x16x32_bf16 v[100:103], a[24:27], a[88:91], v[100:103]
v_exp_f32 v171, v131 clamp
v_mfma_f32_16x16x32_bf16 v[100:103], a[28:31], a[92:95], v[100:103]
ds_read_b64_tr_b16 a[42:43], v222 offset:20480
v_cvt_pk_bf16_f32 v149, v170, v171
v_mfma_f32_16x16x32_bf16 v[104:107], a[0:3], a[96:99], v[160:163]
v_exp_f32 v172, v132 clamp
v_mfma_f32_16x16x32_bf16 v[104:107], a[4:7], a[100:103], v[104:107]
buffer_load_dwordx4 v245, s[16:19], s46 offen offset:1024 nt lds
v_mfma_f32_16x16x32_bf16 v[104:107], a[8:11], a[104:107], v[104:107]
ds_read_b64_tr_b16 a[44:45], v223 offset:16384
ds_read_b64_tr_b16 a[46:47], v223 offset:20480
v_mfma_f32_16x16x32_bf16 v[104:107], a[12:15], a[108:111], v[104:107]
v_exp_f32 v173, v133 clamp
v_mfma_f32_16x16x32_bf16 v[108:111], a[16:19], a[96:99], v[160:163]
ds_read_b64_tr_b16 a[48:49], v224 offset:16384
v_cvt_pk_bf16_f32 v150, v172, v173
v_mfma_f32_16x16x32_bf16 v[108:111], a[20:23], a[100:103], v[108:111]
v_exp_f32 v174, v134 clamp
v_mfma_f32_16x16x32_bf16 v[108:111], a[24:27], a[104:107], v[108:111]
ds_read_b64_tr_b16 a[50:51], v224 offset:20480
ds_read_b64_tr_b16 a[52:53], v225 offset:16384
v_mfma_f32_16x16x32_bf16 v[108:111], a[28:31], a[108:111], v[108:111]
buffer_load_dwordx4 v244, s[16:19], s46 offen offset:2048 nt lds
v_cmp_ngt_f32 vcc, 1.0, v176
v_mfma_f32_16x16x32_bf16 v[112:115], a[0:3], a[112:115], v[164:167]
v_exp_f32 v175, v135 clamp
v_mfma_f32_16x16x32_bf16 v[112:115], a[4:7], a[116:119], v[112:115]
s_cbranch_vccnz L_rs_s5_0
L_rs_s5_0_ret:
ds_read_b64_tr_b16 a[54:55], v225 offset:20480
ds_read_b64_tr_b16 a[56:57], v226 offset:16384
v_mfma_f32_16x16x32_bf16 v[112:115], a[8:11], a[120:123], v[112:115]
ds_read_b64_tr_b16 a[58:59], v226 offset:20480
v_cvt_pk_bf16_f32 v151, v174, v175
v_mfma_f32_16x16x32_bf16 v[112:115], a[12:15], a[124:127], v[112:115]
ds_read_b64_tr_b16 a[60:61], v227 offset:16384
ds_read_b64_tr_b16 a[62:63], v227 offset:20480
v_mfma_f32_16x16x32_bf16 v[116:119], a[16:19], a[112:115], v[164:167]
v_exp_f32 v168, v136 clamp
v_mfma_f32_16x16x32_bf16 v[116:119], a[20:23], a[116:119], v[116:119]
buffer_load_dwordx4 v245, s[16:19], s46 offen offset:3072 nt lds
s_add_u32 s46, s46, 16384
v_mfma_f32_16x16x32_bf16 v[180:183], a[64:67], v[148:151], v[180:183]
v_exp_f32 v169, v137 clamp
v_mfma_f32_16x16x32_bf16 v[116:119], a[24:27], a[120:123], v[116:119]
s_waitcnt lgkmcnt(0)
v_exp_f32 v170, v138 clamp
v_mfma_f32_16x16x32_bf16 v[116:119], a[28:31], a[124:127], v[116:119]
v_exp_f32 v171, v139 clamp
v_mfma_f32_16x16x32_bf16 v[0:3], a[32:35], v[144:147], v[0:3]
ds_read_b128 a[0:3], v216 offset:49152
v_cvt_pk_bf16_f32 v152, v168, v169
v_mfma_f32_16x16x32_bf16 v[12:15], a[36:39], v[144:147], v[12:15]
s_add_u32 m0, s43, 114688
v_exp_f32 v172, v140 clamp
v_mfma_f32_16x16x32_bf16 v[24:27], a[40:43], v[144:147], v[24:27]
buffer_load_dwordx4 v244, s[20:23], s47 offen offset:0 nt lds
v_cmp_ngt_f32 vcc, 1.0, v180
v_mfma_f32_16x16x32_bf16 v[36:39], a[44:47], v[144:147], v[36:39]
ds_read_b128 a[4:7], v217 offset:49152
v_cvt_pk_bf16_f32 v153, v170, v171
v_mfma_f32_16x16x32_bf16 v[48:51], a[48:51], v[144:147], v[48:51]
s_cbranch_vccnz L_rs_s5_1
L_rs_s5_1_ret:
v_exp_f32 v173, v141 clamp
v_mfma_f32_16x16x32_bf16 v[60:63], a[52:55], v[144:147], v[60:63]
v_exp_f32 v174, v142 clamp
v_mfma_f32_16x16x32_bf16 v[72:75], a[56:59], v[144:147], v[72:75]
ds_read_b128 a[8:11], v218 offset:49152
v_cvt_pk_bf16_f32 v154, v172, v173
v_mfma_f32_16x16x32_bf16 v[84:87], a[60:63], v[144:147], v[84:87]
v_exp_f32 v175, v143 clamp
v_mfma_f32_16x16x32_bf16 v[4:7], a[32:35], v[148:151], v[4:7]
buffer_load_dwordx4 v245, s[20:23], s47 offen offset:1024 nt lds
v_mfma_f32_16x16x32_bf16 v[16:19], a[36:39], v[148:151], v[16:19]
ds_read_b128 a[12:15], v219 offset:49152
v_cvt_pk_bf16_f32 v155, v174, v175
v_mfma_f32_16x16x32_bf16 v[28:31], a[40:43], v[148:151], v[28:31]
v_exp_f32 v168, v96 clamp
v_mfma_f32_16x16x32_bf16 v[184:187], a[64:67], v[152:155], v[184:187]
v_exp_f32 v169, v97 clamp
v_mfma_f32_16x16x32_bf16 v[40:43], a[44:47], v[148:151], v[40:43]
ds_read_b128 a[16:19], v216 offset:53248
v_cvt_pk_bf16_f32 v144, v168, v169
v_mfma_f32_16x16x32_bf16 v[52:55], a[48:51], v[148:151], v[52:55]
v_exp_f32 v170, v98 clamp
v_mfma_f32_16x16x32_bf16 v[64:67], a[52:55], v[148:151], v[64:67]
buffer_load_dwordx4 v244, s[20:23], s47 offen offset:2048 nt lds
v_mfma_f32_16x16x32_bf16 v[76:79], a[56:59], v[148:151], v[76:79]
v_exp_f32 v171, v99 clamp
v_cmp_ngt_f32 vcc, 1.0, v184
v_mfma_f32_16x16x32_bf16 v[88:91], a[60:63], v[148:151], v[88:91]
s_cbranch_vccnz L_rs_s5_2
L_rs_s5_2_ret:
ds_read_b128 a[20:23], v217 offset:53248
v_cvt_pk_bf16_f32 v145, v170, v171
v_mfma_f32_16x16x32_bf16 v[8:11], a[32:35], v[152:155], v[8:11]
v_exp_f32 v172, v100 clamp
v_mfma_f32_16x16x32_bf16 v[20:23], a[36:39], v[152:155], v[20:23]
v_exp_f32 v173, v101 clamp
v_mfma_f32_16x16x32_bf16 v[32:35], a[40:43], v[152:155], v[32:35]
ds_read_b128 a[24:27], v218 offset:53248
v_cvt_pk_bf16_f32 v146, v172, v173
v_mfma_f32_16x16x32_bf16 v[44:47], a[44:47], v[152:155], v[44:47]
buffer_load_dwordx4 v245, s[20:23], s47 offen offset:3072 nt lds
s_add_u32 s47, s47, 16384
v_mfma_f32_16x16x32_bf16 v[56:59], a[48:51], v[152:155], v[56:59]
ds_read_b128 a[28:31], v219 offset:53248
v_mfma_f32_16x16x32_bf16 v[68:71], a[52:55], v[152:155], v[68:71]
v_exp_f32 v174, v102 clamp
v_mfma_f32_16x16x32_bf16 v[80:83], a[56:59], v[152:155], v[80:83]
v_exp_f32 v175, v103 clamp
v_mfma_f32_16x16x32_bf16 v[92:95], a[60:63], v[152:155], v[92:95]
s_waitcnt lgkmcnt(1)
v_cvt_pk_bf16_f32 v147, v174, v175
.p2align 3
L_rep:
v_mfma_f32_16x16x32_bf16 v[120:123], a[0:3], a[80:83], v[156:159]
s_waitcnt vmcnt(8)
s_barrier
v_exp_f32 v168, v104 clamp
v_mfma_f32_16x16x32_bf16 v[120:123], a[4:7], a[84:87], v[120:123]
ds_read_b64_tr_b16 a[32:33], v220 offset:32768
ds_read_b64_tr_b16 a[34:35], v220 offset:36864
v_mfma_f32_16x16x32_bf16 v[120:123], a[8:11], a[88:91], v[120:123]
v_exp_f32 v169, v105 clamp
v_mfma_f32_16x16x32_bf16 v[176:179], a[64:67], v[144:147], v[176:179]
s_add_u32 m0, s43, 32768
ds_read_b64_tr_b16 a[36:37], v221 offset:32768
v_cvt_pk_bf16_f32 v148, v168, v169
v_mfma_f32_16x16x32_bf16 v[120:123], a[12:15], a[92:95], v[120:123]
buffer_load_dwordx4 v244, s[16:19], s46 offen offset:0 nt lds
v_mfma_f32_16x16x32_bf16 v[124:127], a[16:19], a[80:83], v[156:159]
v_exp_f32 v170, v106 clamp
v_mfma_f32_16x16x32_bf16 v[124:127], a[20:23], a[84:87], v[124:127]
s_waitcnt lgkmcnt(3)
ds_read_b64_tr_b16 a[38:39], v221 offset:36864
ds_read_b64_tr_b16 a[40:41], v222 offset:32768
v_mfma_f32_16x16x32_bf16 v[124:127], a[24:27], a[88:91], v[124:127]
v_exp_f32 v171, v107 clamp
v_mfma_f32_16x16x32_bf16 v[124:127], a[28:31], a[92:95], v[124:127]
ds_read_b64_tr_b16 a[42:43], v222 offset:36864
v_cvt_pk_bf16_f32 v149, v170, v171
v_mfma_f32_16x16x32_bf16 v[128:131], a[0:3], a[96:99], v[160:163]
v_exp_f32 v172, v108 clamp
v_mfma_f32_16x16x32_bf16 v[128:131], a[4:7], a[100:103], v[128:131]
buffer_load_dwordx4 v245, s[16:19], s46 offen offset:1024 nt lds
v_mfma_f32_16x16x32_bf16 v[128:131], a[8:11], a[104:107], v[128:131]
ds_read_b64_tr_b16 a[44:45], v223 offset:32768
ds_read_b64_tr_b16 a[46:47], v223 offset:36864
v_mfma_f32_16x16x32_bf16 v[128:131], a[12:15], a[108:111], v[128:131]
v_exp_f32 v173, v109 clamp
v_mfma_f32_16x16x32_bf16 v[132:135], a[16:19], a[96:99], v[160:163]
ds_read_b64_tr_b16 a[48:49], v224 offset:32768
v_cvt_pk_bf16_f32 v150, v172, v173
v_mfma_f32_16x16x32_bf16 v[132:135], a[20:23], a[100:103], v[132:135]
v_exp_f32 v174, v110 clamp
v_mfma_f32_16x16x32_bf16 v[132:135], a[24:27], a[104:107], v[132:135]
ds_read_b64_tr_b16 a[50:51], v224 offset:36864
ds_read_b64_tr_b16 a[52:53], v225 offset:32768
v_mfma_f32_16x16x32_bf16 v[132:135], a[28:31], a[108:111], v[132:135]
buffer_load_dwordx4 v244, s[16:19], s46 offen offset:2048 nt lds
v_cmp_ngt_f32 vcc, 1.0, v176
v_mfma_f32_16x16x32_bf16 v[136:139], a[0:3], a[112:115], v[164:167]
v_exp_f32 v175, v111 clamp
v_mfma_f32_16x16x32_bf16 v[136:139], a[4:7], a[116:119], v[136:139]
s_cbranch_vccnz L_rs_s6_0
L_rs_s6_0_ret:
ds_read_b64_tr_b16 a[54:55], v225 offset:36864
ds_read_b64_tr_b16 a[56:57], v226 offset:32768
v_mfma_f32_16x16x32_bf16 v[136:139], a[8:11], a[120:123], v[136:139]
ds_read_b64_tr_b16 a[58:59], v226 offset:36864
v_cvt_pk_bf16_f32 v151, v174, v175
v_mfma_f32_16x16x32_bf16 v[136:139], a[12:15], a[124:127], v[136:139]
ds_read_b64_tr_b16 a[60:61], v227 offset:32768
ds_read_b64_tr_b16 a[62:63], v227 offset:36864
v_mfma_f32_16x16x32_bf16 v[140:143], a[16:19], a[112:115], v[164:167]
v_exp_f32 v168, v112 clamp
v_mfma_f32_16x16x32_bf16 v[140:143], a[20:23], a[116:119], v[140:143]
buffer_load_dwordx4 v245, s[16:19], s46 offen offset:3072 nt lds
s_add_u32 s46, s46, 16384
v_mfma_f32_16x16x32_bf16 v[180:183], a[64:67], v[148:151], v[180:183]
v_exp_f32 v169, v113 clamp
v_mfma_f32_16x16x32_bf16 v[140:143], a[24:27], a[120:123], v[140:143]
s_waitcnt lgkmcnt(0)
v_exp_f32 v170, v114 clamp
v_mfma_f32_16x16x32_bf16 v[140:143], a[28:31], a[124:127], v[140:143]
v_exp_f32 v171, v115 clamp
v_mfma_f32_16x16x32_bf16 v[0:3], a[32:35], v[144:147], v[0:3]
ds_read_b128 a[0:3], v216 offset:0
v_cvt_pk_bf16_f32 v152, v168, v169
v_mfma_f32_16x16x32_bf16 v[12:15], a[36:39], v[144:147], v[12:15]
s_add_u32 m0, s43, 65536
v_exp_f32 v172, v116 clamp
v_mfma_f32_16x16x32_bf16 v[24:27], a[40:43], v[144:147], v[24:27]
buffer_load_dwordx4 v244, s[20:23], s47 offen offset:0 nt lds
v_cmp_ngt_f32 vcc, 1.0, v180
v_mfma_f32_16x16x32_bf16 v[36:39], a[44:47], v[144:147], v[36:39]
ds_read_b128 a[4:7], v217 offset:0
v_cvt_pk_bf16_f32 v153, v170, v171
v_mfma_f32_16x16x32_bf16 v[48:51], a[48:51], v[144:147], v[48:51]
s_cbranch_vccnz L_rs_s6_1
L_rs_s6_1_ret:
v_exp_f32 v173, v117 clamp
v_mfma_f32_16x16x32_bf16 v[60:63], a[52:55], v[144:147], v[60:63]
v_exp_f32 v174, v118 clamp
v_mfma_f32_16x16x32_bf16 v[72:75], a[56:59], v[144:147], v[72:75]
ds_read_b128 a[8:11], v218 offset:0
v_cvt_pk_bf16_f32 v154, v172, v173
v_mfma_f32_16x16x32_bf16 v[84:87], a[60:63], v[144:147], v[84:87]
v_exp_f32 v175, v119 clamp
v_mfma_f32_16x16x32_bf16 v[4:7], a[32:35], v[148:151], v[4:7]
buffer_load_dwordx4 v245, s[20:23], s47 offen offset:1024 nt lds
v_mfma_f32_16x16x32_bf16 v[16:19], a[36:39], v[148:151], v[16:19]
ds_read_b128 a[12:15], v219 offset:0
v_cvt_pk_bf16_f32 v155, v174, v175
v_mfma_f32_16x16x32_bf16 v[28:31], a[40:43], v[148:151], v[28:31]
v_exp_f32 v168, v120 clamp
v_mfma_f32_16x16x32_bf16 v[184:187], a[64:67], v[152:155], v[184:187]
v_exp_f32 v169, v121 clamp
v_mfma_f32_16x16x32_bf16 v[40:43], a[44:47], v[148:151], v[40:43]
ds_read_b128 a[16:19], v216 offset:4096
v_cvt_pk_bf16_f32 v144, v168, v169
v_mfma_f32_16x16x32_bf16 v[52:55], a[48:51], v[148:151], v[52:55]
v_exp_f32 v170, v122 clamp
v_mfma_f32_16x16x32_bf16 v[64:67], a[52:55], v[148:151], v[64:67]
buffer_load_dwordx4 v244, s[20:23], s47 offen offset:2048 nt lds
v_mfma_f32_16x16x32_bf16 v[76:79], a[56:59], v[148:151], v[76:79]
v_exp_f32 v171, v123 clamp
v_cmp_ngt_f32 vcc, 1.0, v184
v_mfma_f32_16x16x32_bf16 v[88:91], a[60:63], v[148:151], v[88:91]
s_cbranch_vccnz L_rs_s6_2
L_rs_s6_2_ret:
ds_read_b128 a[20:23], v217 offset:4096
v_cvt_pk_bf16_f32 v145, v170, v171
v_mfma_f32_16x16x32_bf16 v[8:11], a[32:35], v[152:155], v[8:11]
v_exp_f32 v172, v124 clamp
v_mfma_f32_16x16x32_bf16 v[20:23], a[36:39], v[152:155], v[20:23]
v_exp_f32 v173, v125 clamp
v_mfma_f32_16x16x32_bf16 v[32:35], a[40:43], v[152:155], v[32:35]
ds_read_b128 a[24:27], v218 offset:4096
v_cvt_pk_bf16_f32 v146, v172, v173
v_mfma_f32_16x16x32_bf16 v[44:47], a[44:47], v[152:155], v[44:47]
buffer_load_dwordx4 v245, s[20:23], s47 offen offset:3072 nt lds
s_add_u32 s47, s47, 16384
v_mfma_f32_16x16x32_bf16 v[56:59], a[48:51], v[152:155], v[56:59]
ds_read_b128 a[28:31], v219 offset:4096
v_mfma_f32_16x16x32_bf16 v[68:71], a[52:55], v[152:155], v[68:71]
v_exp_f32 v174, v126 clamp
v_mfma_f32_16x16x32_bf16 v[80:83], a[56:59], v[152:155], v[80:83]
v_exp_f32 v175, v127 clamp
v_mfma_f32_16x16x32_bf16 v[92:95], a[60:63], v[152:155], v[92:95]
s_waitcnt lgkmcnt(1)
v_cvt_pk_bf16_f32 v147, v174, v175
v_mfma_f32_16x16x32_bf16 v[96:99], a[0:3], a[80:83], v[156:159]
s_waitcnt vmcnt(8)
s_barrier
v_exp_f32 v168, v128 clamp
v_mfma_f32_16x16x32_bf16 v[96:99], a[4:7], a[84:87], v[96:99]
ds_read_b64_tr_b16 a[32:33], v220 offset:49152
ds_read_b64_tr_b16 a[34:35], v220 offset:53248
v_mfma_f32_16x16x32_bf16 v[96:99], a[8:11], a[88:91], v[96:99]
v_exp_f32 v169, v129 clamp
v_mfma_f32_16x16x32_bf16 v[176:179], a[64:67], v[144:147], v[176:179]
s_add_u32 m0, s43, 49152
ds_read_b64_tr_b16 a[36:37], v221 offset:49152
v_cvt_pk_bf16_f32 v148, v168, v169
v_mfma_f32_16x16x32_bf16 v[96:99], a[12:15], a[92:95], v[96:99]
buffer_load_dwordx4 v244, s[16:19], s46 offen offset:0 nt lds
v_mfma_f32_16x16x32_bf16 v[100:103], a[16:19], a[80:83], v[156:159]
v_exp_f32 v170, v130 clamp
v_mfma_f32_16x16x32_bf16 v[100:103], a[20:23], a[84:87], v[100:103]
s_waitcnt lgkmcnt(3)
ds_read_b64_tr_b16 a[38:39], v221 offset:53248
ds_read_b64_tr_b16 a[40:41], v222 offset:49152
v_mfma_f32_16x16x32_bf16 v[100:103], a[24:27], a[88:91], v[100:103]
v_exp_f32 v171, v131 clamp
v_mfma_f32_16x16x32_bf16 v[100:103], a[28:31], a[92:95], v[100:103]
ds_read_b64_tr_b16 a[42:43], v222 offset:53248
v_cvt_pk_bf16_f32 v149, v170, v171
v_mfma_f32_16x16x32_bf16 v[104:107], a[0:3], a[96:99], v[160:163]
v_exp_f32 v172, v132 clamp
v_mfma_f32_16x16x32_bf16 v[104:107], a[4:7], a[100:103], v[104:107]
buffer_load_dwordx4 v245, s[16:19], s46 offen offset:1024 nt lds
v_mfma_f32_16x16x32_bf16 v[104:107], a[8:11], a[104:107], v[104:107]
ds_read_b64_tr_b16 a[44:45], v223 offset:49152
ds_read_b64_tr_b16 a[46:47], v223 offset:53248
v_mfma_f32_16x16x32_bf16 v[104:107], a[12:15], a[108:111], v[104:107]
v_exp_f32 v173, v133 clamp
v_mfma_f32_16x16x32_bf16 v[108:111], a[16:19], a[96:99], v[160:163]
ds_read_b64_tr_b16 a[48:49], v224 offset:49152
v_cvt_pk_bf16_f32 v150, v172, v173
v_mfma_f32_16x16x32_bf16 v[108:111], a[20:23], a[100:103], v[108:111]
v_exp_f32 v174, v134 clamp
v_mfma_f32_16x16x32_bf16 v[108:111], a[24:27], a[104:107], v[108:111]
ds_read_b64_tr_b16 a[50:51], v224 offset:53248
ds_read_b64_tr_b16 a[52:53], v225 offset:49152
v_mfma_f32_16x16x32_bf16 v[108:111], a[28:31], a[108:111], v[108:111]
buffer_load_dwordx4 v244, s[16:19], s46 offen offset:2048 nt lds
v_cmp_ngt_f32 vcc, 1.0, v176
v_mfma_f32_16x16x32_bf16 v[112:115], a[0:3], a[112:115], v[164:167]
v_exp_f32 v175, v135 clamp
v_mfma_f32_16x16x32_bf16 v[112:115], a[4:7], a[116:119], v[112:115]
s_cbranch_vccnz L_rs_s7_0
L_rs_s7_0_ret:
ds_read_b64_tr_b16 a[54:55], v225 offset:53248
ds_read_b64_tr_b16 a[56:57], v226 offset:49152
v_mfma_f32_16x16x32_bf16 v[112:115], a[8:11], a[120:123], v[112:115]
ds_read_b64_tr_b16 a[58:59], v226 offset:53248
v_cvt_pk_bf16_f32 v151, v174, v175
v_mfma_f32_16x16x32_bf16 v[112:115], a[12:15], a[124:127], v[112:115]
ds_read_b64_tr_b16 a[60:61], v227 offset:49152
ds_read_b64_tr_b16 a[62:63], v227 offset:53248
v_mfma_f32_16x16x32_bf16 v[116:119], a[16:19], a[112:115], v[164:167]
v_exp_f32 v168, v136 clamp
v_mfma_f32_16x16x32_bf16 v[116:119], a[20:23], a[116:119], v[116:119]
buffer_load_dwordx4 v245, s[16:19], s46 offen offset:3072 nt lds
s_add_u32 s46, s46, 16384
v_mfma_f32_16x16x32_bf16 v[180:183], a[64:67], v[148:151], v[180:183]
v_exp_f32 v169, v137 clamp
v_mfma_f32_16x16x32_bf16 v[116:119], a[24:27], a[120:123], v[116:119]
s_waitcnt lgkmcnt(0)
v_exp_f32 v170, v138 clamp
v_mfma_f32_16x16x32_bf16 v[116:119], a[28:31], a[124:127], v[116:119]
v_exp_f32 v171, v139 clamp
v_mfma_f32_16x16x32_bf16 v[0:3], a[32:35], v[144:147], v[0:3]
ds_read_b128 a[0:3], v216 offset:16384
v_cvt_pk_bf16_f32 v152, v168, v169
v_mfma_f32_16x16x32_bf16 v[12:15], a[36:39], v[144:147], v[12:15]
s_add_u32 m0, s43, 81920
v_exp_f32 v172, v140 clamp
v_mfma_f32_16x16x32_bf16 v[24:27], a[40:43], v[144:147], v[24:27]
buffer_load_dwordx4 v244, s[20:23], s47 offen offset:0 nt lds
v_cmp_ngt_f32 vcc, 1.0, v180
v_mfma_f32_16x16x32_bf16 v[36:39], a[44:47], v[144:147], v[36:39]
ds_read_b128 a[4:7], v217 offset:16384
v_cvt_pk_bf16_f32 v153, v170, v171
v_mfma_f32_16x16x32_bf16 v[48:51], a[48:51], v[144:147], v[48:51]
s_cbranch_vccnz L_rs_s7_1
L_rs_s7_1_ret:
v_exp_f32 v173, v141 clamp
v_mfma_f32_16x16x32_bf16 v[60:63], a[52:55], v[144:147], v[60:63]
v_exp_f32 v174, v142 clamp
v_mfma_f32_16x16x32_bf16 v[72:75], a[56:59], v[144:147], v[72:75]
ds_read_b128 a[8:11], v218 offset:16384
v_cvt_pk_bf16_f32 v154, v172, v173
v_mfma_f32_16x16x32_bf16 v[84:87], a[60:63], v[144:147], v[84:87]
v_exp_f32 v175, v143 clamp
v_mfma_f32_16x16x32_bf16 v[4:7], a[32:35], v[148:151], v[4:7]
buffer_load_dwordx4 v245, s[20:23], s47 offen offset:1024 nt lds
v_mfma_f32_16x16x32_bf16 v[16:19], a[36:39], v[148:151], v[16:19]
ds_read_b128 a[12:15], v219 offset:16384
v_cvt_pk_bf16_f32 v155, v174, v175
v_mfma_f32_16x16x32_bf16 v[28:31], a[40:43], v[148:151], v[28:31]
v_exp_f32 v168, v96 clamp
v_mfma_f32_16x16x32_bf16 v[184:187], a[64:67], v[152:155], v[184:187]
v_exp_f32 v169, v97 clamp
v_mfma_f32_16x16x32_bf16 v[40:43], a[44:47], v[148:151], v[40:43]
ds_read_b128 a[16:19], v216 offset:20480
v_cvt_pk_bf16_f32 v144, v168, v169
v_mfma_f32_16x16x32_bf16 v[52:55], a[48:51], v[148:151], v[52:55]
v_exp_f32 v170, v98 clamp
v_mfma_f32_16x16x32_bf16 v[64:67], a[52:55], v[148:151], v[64:67]
buffer_load_dwordx4 v244, s[20:23], s47 offen offset:2048 nt lds
v_mfma_f32_16x16x32_bf16 v[76:79], a[56:59], v[148:151], v[76:79]
v_exp_f32 v171, v99 clamp
v_cmp_ngt_f32 vcc, 1.0, v184
v_mfma_f32_16x16x32_bf16 v[88:91], a[60:63], v[148:151], v[88:91]
s_cbranch_vccnz L_rs_s7_2
L_rs_s7_2_ret:
ds_read_b128 a[20:23], v217 offset:20480
v_cvt_pk_bf16_f32 v145, v170, v171
v_mfma_f32_16x16x32_bf16 v[8:11], a[32:35], v[152:155], v[8:11]
v_exp_f32 v172, v100 clamp
v_mfma_f32_16x16x32_bf16 v[20:23], a[36:39], v[152:155], v[20:23]
v_exp_f32 v173, v101 clamp
v_mfma_f32_16x16x32_bf16 v[32:35], a[40:43], v[152:155], v[32:35]
ds_read_b128 a[24:27], v218 offset:20480
v_cvt_pk_bf16_f32 v146, v172, v173
v_mfma_f32_16x16x32_bf16 v[44:47], a[44:47], v[152:155], v[44:47]
buffer_load_dwordx4 v245, s[20:23], s47 offen offset:3072 nt lds
s_add_u32 s47, s47, 16384
v_mfma_f32_16x16x32_bf16 v[56:59], a[48:51], v[152:155], v[56:59]
ds_read_b128 a[28:31], v219 offset:20480
v_mfma_f32_16x16x32_bf16 v[68:71], a[52:55], v[152:155], v[68:71]
v_exp_f32 v174, v102 clamp
v_mfma_f32_16x16x32_bf16 v[80:83], a[56:59], v[152:155], v[80:83]
v_exp_f32 v175, v103 clamp
v_mfma_f32_16x16x32_bf16 v[92:95], a[60:63], v[152:155], v[92:95]
s_waitcnt lgkmcnt(1)
v_cvt_pk_bf16_f32 v147, v174, v175
v_mfma_f32_16x16x32_bf16 v[120:123], a[0:3], a[80:83], v[156:159]
s_waitcnt vmcnt(8)
s_barrier
v_exp_f32 v168, v104 clamp
v_mfma_f32_16x16x32_bf16 v[120:123], a[4:7], a[84:87], v[120:123]
ds_read_b64_tr_b16 a[32:33], v220 offset:0
ds_read_b64_tr_b16 a[34:35], v220 offset:4096
v_mfma_f32_16x16x32_bf16 v[120:123], a[8:11], a[88:91], v[120:123]
v_exp_f32 v169, v105 clamp
v_mfma_f32_16x16x32_bf16 v[176:179], a[64:67], v[144:147], v[176:179]
s_add_u32 m0, s43, 0
ds_read_b64_tr_b16 a[36:37], v221 offset:0
v_cvt_pk_bf16_f32 v148, v168, v169
v_mfma_f32_16x16x32_bf16 v[120:123], a[12:15], a[92:95], v[120:123]
buffer_load_dwordx4 v244, s[16:19], s46 offen offset:0 nt lds
v_mfma_f32_16x16x32_bf16 v[124:127], a[16:19], a[80:83], v[156:159]
v_exp_f32 v170, v106 clamp
v_mfma_f32_16x16x32_bf16 v[124:127], a[20:23], a[84:87], v[124:127]
s_waitcnt lgkmcnt(3)
ds_read_b64_tr_b16 a[38:39], v221 offset:4096
ds_read_b64_tr_b16 a[40:41], v222 offset:0
v_mfma_f32_16x16x32_bf16 v[124:127], a[24:27], a[88:91], v[124:127]
v_exp_f32 v171, v107 clamp
v_mfma_f32_16x16x32_bf16 v[124:127], a[28:31], a[92:95], v[124:127]
ds_read_b64_tr_b16 a[42:43], v222 offset:4096
v_cvt_pk_bf16_f32 v149, v170, v171
v_mfma_f32_16x16x32_bf16 v[128:131], a[0:3], a[96:99], v[160:163]
v_exp_f32 v172, v108 clamp
v_mfma_f32_16x16x32_bf16 v[128:131], a[4:7], a[100:103], v[128:131]
buffer_load_dwordx4 v245, s[16:19], s46 offen offset:1024 nt lds
v_mfma_f32_16x16x32_bf16 v[128:131], a[8:11], a[104:107], v[128:131]
ds_read_b64_tr_b16 a[44:45], v223 offset:0
ds_read_b64_tr_b16 a[46:47], v223 offset:4096
v_mfma_f32_16x16x32_bf16 v[128:131], a[12:15], a[108:111], v[128:131]
v_exp_f32 v173, v109 clamp
v_mfma_f32_16x16x32_bf16 v[132:135], a[16:19], a[96:99], v[160:163]
ds_read_b64_tr_b16 a[48:49], v224 offset:0
v_cvt_pk_bf16_f32 v150, v172, v173
v_mfma_f32_16x16x32_bf16 v[132:135], a[20:23], a[100:103], v[132:135]
v_exp_f32 v174, v110 clamp
v_mfma_f32_16x16x32_bf16 v[132:135], a[24:27], a[104:107], v[132:135]
ds_read_b64_tr_b16 a[50:51], v224 offset:4096
ds_read_b64_tr_b16 a[52:53], v225 offset:0
v_mfma_f32_16x16x32_bf16 v[132:135], a[28:31], a[108:111], v[132:135]
buffer_load_dwordx4 v244, s[16:19], s46 offen offset:2048 nt lds
v_cmp_ngt_f32 vcc, 1.0, v176
v_mfma_f32_16x16x32_bf16 v[136:139], a[0:3], a[112:115], v[164:167]
v_exp_f32 v175, v111 clamp
v_mfma_f32_16x16x32_bf16 v[136:139], a[4:7], a[116:119], v[136:139]
s_cbranch_vccnz L_rs_s8_0
L_rs_s8_0_ret:
ds_read_b64_tr_b16 a[54:55], v225 offset:4096
ds_read_b64_tr_b16 a[56:57], v226 offset:0
v_mfma_f32_16x16x32_bf16 v[136:139], a[8:11], a[120:123], v[136:139]
ds_read_b64_tr_b16 a[58:59], v226 offset:4096
v_cvt_pk_bf16_f32 v151, v174, v175
v_mfma_f32_16x16x32_bf16 v[136:139], a[12:15], a[124:127], v[136:139]
ds_read_b64_tr_b16 a[60:61], v227 offset:0
ds_read_b64_tr_b16 a[62:63], v227 offset:4096
v_mfma_f32_16x16x32_bf16 v[140:143], a[16:19], a[112:115], v[164:167]
v_exp_f32 v168, v112 clamp
v_mfma_f32_16x16x32_bf16 v[140:143], a[20:23], a[116:119], v[140:143]
buffer_load_dwordx4 v245, s[16:19], s46 offen offset:3072 nt lds
s_add_u32 s46, s46, 16384
v_mfma_f32_16x16x32_bf16 v[180:183], a[64:67], v[148:151], v[180:183]
v_exp_f32 v169, v113 clamp
v_mfma_f32_16x16x32_bf16 v[140:143], a[24:27], a[120:123], v[140:143]
s_waitcnt lgkmcnt(0)
v_exp_f32 v170, v114 clamp
v_mfma_f32_16x16x32_bf16 v[140:143], a[28:31], a[124:127], v[140:143]
v_exp_f32 v171, v115 clamp
v_mfma_f32_16x16x32_bf16 v[0:3], a[32:35], v[144:147], v[0:3]
ds_read_b128 a[0:3], v216 offset:32768
v_cvt_pk_bf16_f32 v152, v168, v169
v_mfma_f32_16x16x32_bf16 v[12:15], a[36:39], v[144:147], v[12:15]
s_add_u32 m0, s43, 98304
v_exp_f32 v172, v116 clamp
v_mfma_f32_16x16x32_bf16 v[24:27], a[40:43], v[144:147], v[24:27]
buffer_load_dwordx4 v244, s[20:23], s47 offen offset:0 nt lds
v_cmp_ngt_f32 vcc, 1.0, v180
v_mfma_f32_16x16x32_bf16 v[36:39], a[44:47], v[144:147], v[36:39]
ds_read_b128 a[4:7], v217 offset:32768
v_cvt_pk_bf16_f32 v153, v170, v171
v_mfma_f32_16x16x32_bf16 v[48:51], a[48:51], v[144:147], v[48:51]
s_cbranch_vccnz L_rs_s8_1
L_rs_s8_1_ret:
v_exp_f32 v173, v117 clamp
v_mfma_f32_16x16x32_bf16 v[60:63], a[52:55], v[144:147], v[60:63]
v_exp_f32 v174, v118 clamp
v_mfma_f32_16x16x32_bf16 v[72:75], a[56:59], v[144:147], v[72:75]
ds_read_b128 a[8:11], v218 offset:32768
v_cvt_pk_bf16_f32 v154, v172, v173
v_mfma_f32_16x16x32_bf16 v[84:87], a[60:63], v[144:147], v[84:87]
v_exp_f32 v175, v119 clamp
v_mfma_f32_16x16x32_bf16 v[4:7], a[32:35], v[148:151], v[4:7]
buffer_load_dwordx4 v245, s[20:23], s47 offen offset:1024 nt lds
v_mfma_f32_16x16x32_bf16 v[16:19], a[36:39], v[148:151], v[16:19]
ds_read_b128 a[12:15], v219 offset:32768
v_cvt_pk_bf16_f32 v155, v174, v175
v_mfma_f32_16x16x32_bf16 v[28:31], a[40:43], v[148:151], v[28:31]
v_exp_f32 v168, v120 clamp
v_mfma_f32_16x16x32_bf16 v[184:187], a[64:67], v[152:155], v[184:187]
v_exp_f32 v169, v121 clamp
v_mfma_f32_16x16x32_bf16 v[40:43], a[44:47], v[148:151], v[40:43]
ds_read_b128 a[16:19], v216 offset:36864
v_cvt_pk_bf16_f32 v144, v168, v169
v_mfma_f32_16x16x32_bf16 v[52:55], a[48:51], v[148:151], v[52:55]
v_exp_f32 v170, v122 clamp
v_mfma_f32_16x16x32_bf16 v[64:67], a[52:55], v[148:151], v[64:67]
buffer_load_dwordx4 v244, s[20:23], s47 offen offset:2048 nt lds
v_mfma_f32_16x16x32_bf16 v[76:79], a[56:59], v[148:151], v[76:79]
v_exp_f32 v171, v123 clamp
v_cmp_ngt_f32 vcc, 1.0, v184
v_mfma_f32_16x16x32_bf16 v[88:91], a[60:63], v[148:151], v[88:91]
s_cbranch_vccnz L_rs_s8_2
L_rs_s8_2_ret:
ds_read_b128 a[20:23], v217 offset:36864
v_cvt_pk_bf16_f32 v145, v170, v171
v_mfma_f32_16x16x32_bf16 v[8:11], a[32:35], v[152:155], v[8:11]
v_exp_f32 v172, v124 clamp
v_mfma_f32_16x16x32_bf16 v[20:23], a[36:39], v[152:155], v[20:23]
v_exp_f32 v173, v125 clamp
v_mfma_f32_16x16x32_bf16 v[32:35], a[40:43], v[152:155], v[32:35]
ds_read_b128 a[24:27], v218 offset:36864
v_cvt_pk_bf16_f32 v146, v172, v173
v_mfma_f32_16x16x32_bf16 v[44:47], a[44:47], v[152:155], v[44:47]
buffer_load_dwordx4 v245, s[20:23], s47 offen offset:3072 nt lds
s_add_u32 s47, s47, 16384
v_mfma_f32_16x16x32_bf16 v[56:59], a[48:51], v[152:155], v[56:59]
ds_read_b128 a[28:31], v219 offset:36864
v_mfma_f32_16x16x32_bf16 v[68:71], a[52:55], v[152:155], v[68:71]
v_exp_f32 v174, v126 clamp
v_mfma_f32_16x16x32_bf16 v[80:83], a[56:59], v[152:155], v[80:83]
v_exp_f32 v175, v127 clamp
v_mfma_f32_16x16x32_bf16 v[92:95], a[60:63], v[152:155], v[92:95]
s_waitcnt lgkmcnt(1)
v_cvt_pk_bf16_f32 v147, v174, v175
v_mfma_f32_16x16x32_bf16 v[96:99], a[0:3], a[80:83], v[156:159]
s_waitcnt vmcnt(8)
s_barrier
v_exp_f32 v168, v128 clamp
v_mfma_f32_16x16x32_bf16 v[96:99], a[4:7], a[84:87], v[96:99]
ds_read_b64_tr_b16 a[32:33], v220 offset:16384
ds_read_b64_tr_b16 a[34:35], v220 offset:20480
v_mfma_f32_16x16x32_bf16 v[96:99], a[8:11], a[88:91], v[96:99]
v_exp_f32 v169, v129 clamp
v_mfma_f32_16x16x32_bf16 v[176:179], a[64:67], v[144:147], v[176:179]
s_add_u32 m0, s43, 16384
ds_read_b64_tr_b16 a[36:37], v221 offset:16384
v_cvt_pk_bf16_f32 v148, v168, v169
v_mfma_f32_16x16x32_bf16 v[96:99], a[12:15], a[92:95], v[96:99]
buffer_load_dwordx4 v244, s[16:19], s46 offen offset:0 nt lds
v_mfma_f32_16x16x32_bf16 v[100:103], a[16:19], a[80:83], v[156:159]
v_exp_f32 v170, v130 clamp
v_mfma_f32_16x16x32_bf16 v[100:103], a[20:23], a[84:87], v[100:103]
s_waitcnt lgkmcnt(3)
ds_read_b64_tr_b16 a[38:39], v221 offset:20480
ds_read_b64_tr_b16 a[40:41], v222 offset:16384
v_mfma_f32_16x16x32_bf16 v[100:103], a[24:27], a[88:91], v[100:103]
v_exp_f32 v171, v131 clamp
v_mfma_f32_16x16x32_bf16 v[100:103], a[28:31], a[92:95], v[100:103]
ds_read_b64_tr_b16 a[42:43], v222 offset:20480
v_cvt_pk_bf16_f32 v149, v170, v171
v_mfma_f32_16x16x32_bf16 v[104:107], a[0:3], a[96:99], v[160:163]
v_exp_f32 v172, v132 clamp
v_mfma_f32_16x16x32_bf16 v[104:107], a[4:7], a[100:103], v[104:107]
buffer_load_dwordx4 v245, s[16:19], s46 offen offset:1024 nt lds
v_mfma_f32_16x16x32_bf16 v[104:107], a[8:11], a[104:107], v[104:107]
ds_read_b64_tr_b16 a[44:45], v223 offset:16384
ds_read_b64_tr_b16 a[46:47], v223 offset:20480
v_mfma_f32_16x16x32_bf16 v[104:107], a[12:15], a[108:111], v[104:107]
v_exp_f32 v173, v133 clamp
v_mfma_f32_16x16x32_bf16 v[108:111], a[16:19], a[96:99], v[160:163]
ds_read_b64_tr_b16 a[48:49], v224 offset:16384
v_cvt_pk_bf16_f32 v150, v172, v173
v_mfma_f32_16x16x32_bf16 v[108:111], a[20:23], a[100:103], v[108:111]
v_exp_f32 v174, v134 clamp
v_mfma_f32_16x16x32_bf16 v[108:111], a[24:27], a[104:107], v[108:111]
ds_read_b64_tr_b16 a[50:51], v224 offset:20480
ds_read_b64_tr_b16 a[52:53], v225 offset:16384
v_mfma_f32_16x16x32_bf16 v[108:111], a[28:31], a[108:111], v[108:111]
buffer_load_dwordx4 v244, s[16:19], s46 offen offset:2048 nt lds
v_cmp_ngt_f32 vcc, 1.0, v176
v_mfma_f32_16x16x32_bf16 v[112:115], a[0:3], a[112:115], v[164:167]
v_exp_f32 v175, v135 clamp
v_mfma_f32_16x16x32_bf16 v[112:115], a[4:7], a[116:119], v[112:115]
s_cbranch_vccnz L_rs_s9_0
L_rs_s9_0_ret:
ds_read_b64_tr_b16 a[54:55], v225 offset:20480
ds_read_b64_tr_b16 a[56:57], v226 offset:16384
v_mfma_f32_16x16x32_bf16 v[112:115], a[8:11], a[120:123], v[112:115]
ds_read_b64_tr_b16 a[58:59], v226 offset:20480
v_cvt_pk_bf16_f32 v151, v174, v175
v_mfma_f32_16x16x32_bf16 v[112:115], a[12:15], a[124:127], v[112:115]
ds_read_b64_tr_b16 a[60:61], v227 offset:16384
ds_read_b64_tr_b16 a[62:63], v227 offset:20480
v_mfma_f32_16x16x32_bf16 v[116:119], a[16:19], a[112:115], v[164:167]
v_exp_f32 v168, v136 clamp
v_mfma_f32_16x16x32_bf16 v[116:119], a[20:23], a[116:119], v[116:119]
buffer_load_dwordx4 v245, s[16:19], s46 offen offset:3072 nt lds
s_add_u32 s46, s46, 16384
v_mfma_f32_16x16x32_bf16 v[180:183], a[64:67], v[148:151], v[180:183]
v_exp_f32 v169, v137 clamp
v_mfma_f32_16x16x32_bf16 v[116:119], a[24:27], a[120:123], v[116:119]
s_waitcnt lgkmcnt(0)
v_exp_f32 v170, v138 clamp
v_mfma_f32_16x16x32_bf16 v[116:119], a[28:31], a[124:127], v[116:119]
v_exp_f32 v171, v139 clamp
v_mfma_f32_16x16x32_bf16 v[0:3], a[32:35], v[144:147], v[0:3]
ds_read_b128 a[0:3], v216 offset:49152
v_cvt_pk_bf16_f32 v152, v168, v169
v_mfma_f32_16x16x32_bf16 v[12:15], a[36:39], v[144:147], v[12:15]
s_add_u32 m0, s43, 114688
v_exp_f32 v172, v140 clamp
v_mfma_f32_16x16x32_bf16 v[24:27], a[40:43], v[144:147], v[24:27]
buffer_load_dwordx4 v244, s[20:23], s47 offen offset:0 nt lds
v_cmp_ngt_f32 vcc, 1.0, v180
v_mfma_f32_16x16x32_bf16 v[36:39], a[44:47], v[144:147], v[36:39]
ds_read_b128 a[4:7], v217 offset:49152
v_cvt_pk_bf16_f32 v153, v170, v171
v_mfma_f32_16x16x32_bf16 v[48:51], a[48:51], v[144:147], v[48:51]
s_cbranch_vccnz L_rs_s9_1
L_rs_s9_1_ret:
v_exp_f32 v173, v141 clamp
v_mfma_f32_16x16x32_bf16 v[60:63], a[52:55], v[144:147], v[60:63]
v_exp_f32 v174, v142 clamp
v_mfma_f32_16x16x32_bf16 v[72:75], a[56:59], v[144:147], v[72:75]
ds_read_b128 a[8:11], v218 offset:49152
v_cvt_pk_bf16_f32 v154, v172, v173
v_mfma_f32_16x16x32_bf16 v[84:87], a[60:63], v[144:147], v[84:87]
v_exp_f32 v175, v143 clamp
v_mfma_f32_16x16x32_bf16 v[4:7], a[32:35], v[148:151], v[4:7]
buffer_load_dwordx4 v245, s[20:23], s47 offen offset:1024 nt lds
v_mfma_f32_16x16x32_bf16 v[16:19], a[36:39], v[148:151], v[16:19]
ds_read_b128 a[12:15], v219 offset:49152
v_cvt_pk_bf16_f32 v155, v174, v175
v_mfma_f32_16x16x32_bf16 v[28:31], a[40:43], v[148:151], v[28:31]
v_exp_f32 v168, v96 clamp
v_mfma_f32_16x16x32_bf16 v[184:187], a[64:67], v[152:155], v[184:187]
v_exp_f32 v169, v97 clamp
v_mfma_f32_16x16x32_bf16 v[40:43], a[44:47], v[148:151], v[40:43]
ds_read_b128 a[16:19], v216 offset:53248
v_cvt_pk_bf16_f32 v144, v168, v169
v_mfma_f32_16x16x32_bf16 v[52:55], a[48:51], v[148:151], v[52:55]
v_exp_f32 v170, v98 clamp
v_mfma_f32_16x16x32_bf16 v[64:67], a[52:55], v[148:151], v[64:67]
buffer_load_dwordx4 v244, s[20:23], s47 offen offset:2048 nt lds
v_mfma_f32_16x16x32_bf16 v[76:79], a[56:59], v[148:151], v[76:79]
v_exp_f32 v171, v99 clamp
v_cmp_ngt_f32 vcc, 1.0, v184
v_mfma_f32_16x16x32_bf16 v[88:91], a[60:63], v[148:151], v[88:91]
s_cbranch_vccnz L_rs_s9_2
L_rs_s9_2_ret:
ds_read_b128 a[20:23], v217 offset:53248
v_cvt_pk_bf16_f32 v145, v170, v171
v_mfma_f32_16x16x32_bf16 v[8:11], a[32:35], v[152:155], v[8:11]
v_exp_f32 v172, v100 clamp
v_mfma_f32_16x16x32_bf16 v[20:23], a[36:39], v[152:155], v[20:23]
v_exp_f32 v173, v101 clamp
v_mfma_f32_16x16x32_bf16 v[32:35], a[40:43], v[152:155], v[32:35]
ds_read_b128 a[24:27], v218 offset:53248
v_cvt_pk_bf16_f32 v146, v172, v173
v_mfma_f32_16x16x32_bf16 v[44:47], a[44:47], v[152:155], v[44:47]
buffer_load_dwordx4 v245, s[20:23], s47 offen offset:3072 nt lds
s_add_u32 s47, s47, 16384
v_mfma_f32_16x16x32_bf16 v[56:59], a[48:51], v[152:155], v[56:59]
ds_read_b128 a[28:31], v219 offset:53248
v_mfma_f32_16x16x32_bf16 v[68:71], a[52:55], v[152:155], v[68:71]
v_exp_f32 v174, v102 clamp
v_mfma_f32_16x16x32_bf16 v[80:83], a[56:59], v[152:155], v[80:83]
v_exp_f32 v175, v103 clamp
v_mfma_f32_16x16x32_bf16 v[92:95], a[60:63], v[152:155], v[92:95]
s_waitcnt lgkmcnt(1)
v_cvt_pk_bf16_f32 v147, v174, v175
s_sub_u32 s45, s45, 1
s_cbranch_scc0 L_rep
v_mfma_f32_16x16x32_bf16 v[120:123], a[0:3], a[80:83], v[156:159]
s_waitcnt vmcnt(8)
s_barrier
v_exp_f32 v168, v104 clamp
v_mfma_f32_16x16x32_bf16 v[120:123], a[4:7], a[84:87], v[120:123]
ds_read_b64_tr_b16 a[32:33], v220 offset:32768
ds_read_b64_tr_b16 a[34:35], v220 offset:36864
v_mfma_f32_16x16x32_bf16 v[120:123], a[8:11], a[88:91], v[120:123]
v_exp_f32 v169, v105 clamp
v_mfma_f32_16x16x32_bf16 v[176:179], a[64:67], v[144:147], v[176:179]
s_add_u32 m0, s43, 65536
ds_read_b64_tr_b16 a[36:37], v221 offset:32768
v_cvt_pk_bf16_f32 v148, v168, v169
v_mfma_f32_16x16x32_bf16 v[120:123], a[12:15], a[92:95], v[120:123]
buffer_load_dwordx4 v244, s[20:23], s47 offen offset:0 nt lds
v_mfma_f32_16x16x32_bf16 v[124:127], a[16:19], a[80:83], v[156:159]
v_exp_f32 v170, v106 clamp
v_mfma_f32_16x16x32_bf16 v[124:127], a[20:23], a[84:87], v[124:127]
s_waitcnt lgkmcnt(3)
ds_read_b64_tr_b16 a[38:39], v221 offset:36864
ds_read_b64_tr_b16 a[40:41], v222 offset:32768
v_mfma_f32_16x16x32_bf16 v[124:127], a[24:27], a[88:91], v[124:127]
v_exp_f32 v171, v107 clamp
v_mfma_f32_16x16x32_bf16 v[124:127], a[28:31], a[92:95], v[124:127]
ds_read_b64_tr_b16 a[42:43], v222 offset:36864
v_cvt_pk_bf16_f32 v149, v170, v171
v_mfma_f32_16x16x32_bf16 v[128:131], a[0:3], a[96:99], v[160:163]
v_exp_f32 v172, v108 clamp
v_mfma_f32_16x16x32_bf16 v[128:131], a[4:7], a[100:103], v[128:131]
buffer_load_dwordx4 v245, s[20:23], s47 offen offset:1024 nt lds
v_mfma_f32_16x16x32_bf16 v[128:131], a[8:11], a[104:107], v[128:131]
ds_read_b64_tr_b16 a[44:45], v223 offset:32768
ds_read_b64_tr_b16 a[46:47], v223 offset:36864
v_mfma_f32_16x16x32_bf16 v[128:131], a[12:15], a[108:111], v[128:131]
v_exp_f32 v173, v109 clamp
v_mfma_f32_16x16x32_bf16 v[132:135], a[16:19], a[96:99], v[160:163]
ds_read_b64_tr_b16 a[48:49], v224 offset:32768
v_cvt_pk_bf16_f32 v150, v172, v173
v_mfma_f32_16x16x32_bf16 v[132:135], a[20:23], a[100:103], v[132:135]
v_exp_f32 v174, v110 clamp
v_mfma_f32_16x16x32_bf16 v[132:135], a[24:27], a[104:107], v[132:135]
ds_read_b64_tr_b16 a[50:51], v224 offset:36864
ds_read_b64_tr_b16 a[52:53], v225 offset:32768
v_mfma_f32_16x16x32_bf16 v[132:135], a[28:31], a[108:111], v[132:135]
buffer_load_dwordx4 v244, s[20:23], s47 offen offset:2048 nt lds
v_cmp_ngt_f32 vcc, 1.0, v176
v_mfma_f32_16x16x32_bf16 v[136:139], a[0:3], a[112:115], v[164:167]
v_exp_f32 v175, v111 clamp
v_mfma_f32_16x16x32_bf16 v[136:139], a[4:7], a[116:119], v[136:139]
s_cbranch_vccnz L_rs_s10_0
L_rs_s10_0_ret:
ds_read_b64_tr_b16 a[54:55], v225 offset:36864
ds_read_b64_tr_b16 a[56:57], v226 offset:32768
v_mfma_f32_16x16x32_bf16 v[136:139], a[8:11], a[120:123], v[136:139]
ds_read_b64_tr_b16 a[58:59], v226 offset:36864
v_cvt_pk_bf16_f32 v151, v174, v175
v_mfma_f32_16x16x32_bf16 v[136:139], a[12:15], a[124:127], v[136:139]
ds_read_b64_tr_b16 a[60:61], v227 offset:32768
ds_read_b64_tr_b16 a[62:63], v227 offset:36864
v_mfma_f32_16x16x32_bf16 v[140:143], a[16:19], a[112:115], v[164:167]
v_exp_f32 v168, v112 clamp
v_mfma_f32_16x16x32_bf16 v[140:143], a[20:23], a[116:119], v[140:143]
buffer_load_dwordx4 v245, s[20:23], s47 offen offset:3072 nt lds
s_add_u32 s47, s47, 16384
v_mfma_f32_16x16x32_bf16 v[180:183], a[64:67], v[148:151], v[180:183]
v_exp_f32 v169, v113 clamp
v_mfma_f32_16x16x32_bf16 v[140:143], a[24:27], a[120:123], v[140:143]
s_waitcnt lgkmcnt(0)
v_exp_f32 v170, v114 clamp
v_mfma_f32_16x16x32_bf16 v[140:143], a[28:31], a[124:127], v[140:143]
v_exp_f32 v171, v115 clamp
v_mfma_f32_16x16x32_bf16 v[0:3], a[32:35], v[144:147], v[0:3]
ds_read_b128 a[0:3], v216 offset:0
v_cvt_pk_bf16_f32 v152, v168, v169
v_mfma_f32_16x16x32_bf16 v[12:15], a[36:39], v[144:147], v[12:15]
s_add_u32 m0, s43, 81920
v_exp_f32 v172, v116 clamp
v_mfma_f32_16x16x32_bf16 v[24:27], a[40:43], v[144:147], v[24:27]
buffer_load_dwordx4 v244, s[20:23], s47 offen offset:0 nt lds
v_cmp_ngt_f32 vcc, 1.0, v180
v_mfma_f32_16x16x32_bf16 v[36:39], a[44:47], v[144:147], v[36:39]
ds_read_b128 a[4:7], v217 offset:0
v_cvt_pk_bf16_f32 v153, v170, v171
v_mfma_f32_16x16x32_bf16 v[48:51], a[48:51], v[144:147], v[48:51]
s_cbranch_vccnz L_rs_s10_1
L_rs_s10_1_ret:
v_exp_f32 v173, v117 clamp
v_mfma_f32_16x16x32_bf16 v[60:63], a[52:55], v[144:147], v[60:63]
v_exp_f32 v174, v118 clamp
v_mfma_f32_16x16x32_bf16 v[72:75], a[56:59], v[144:147], v[72:75]
ds_read_b128 a[8:11], v218 offset:0
v_cvt_pk_bf16_f32 v154, v172, v173
v_mfma_f32_16x16x32_bf16 v[84:87], a[60:63], v[144:147], v[84:87]
v_exp_f32 v175, v119 clamp
v_mfma_f32_16x16x32_bf16 v[4:7], a[32:35], v[148:151], v[4:7]
buffer_load_dwordx4 v245, s[20:23], s47 offen offset:1024 nt lds
v_mfma_f32_16x16x32_bf16 v[16:19], a[36:39], v[148:151], v[16:19]
ds_read_b128 a[12:15], v219 offset:0
v_cvt_pk_bf16_f32 v155, v174, v175
v_mfma_f32_16x16x32_bf16 v[28:31], a[40:43], v[148:151], v[28:31]
v_exp_f32 v168, v120 clamp
v_mfma_f32_16x16x32_bf16 v[184:187], a[64:67], v[152:155], v[184:187]
v_exp_f32 v169, v121 clamp
v_mfma_f32_16x16x32_bf16 v[40:43], a[44:47], v[148:151], v[40:43]
ds_read_b128 a[16:19], v216 offset:4096
v_cvt_pk_bf16_f32 v144, v168, v169
v_mfma_f32_16x16x32_bf16 v[52:55], a[48:51], v[148:151], v[52:55]
v_exp_f32 v170, v122 clamp
v_mfma_f32_16x16x32_bf16 v[64:67], a[52:55], v[148:151], v[64:67]
buffer_load_dwordx4 v244, s[20:23], s47 offen offset:2048 nt lds
v_mfma_f32_16x16x32_bf16 v[76:79], a[56:59], v[148:151], v[76:79]
v_exp_f32 v171, v123 clamp
v_cmp_ngt_f32 vcc, 1.0, v184
v_mfma_f32_16x16x32_bf16 v[88:91], a[60:63], v[148:151], v[88:91]
s_cbranch_vccnz L_rs_s10_2
L_rs_s10_2_ret:
ds_read_b128 a[20:23], v217 offset:4096
v_cvt_pk_bf16_f32 v145, v170, v171
v_mfma_f32_16x16x32_bf16 v[8:11], a[32:35], v[152:155], v[8:11]
v_exp_f32 v172, v124 clamp
v_mfma_f32_16x16x32_bf16 v[20:23], a[36:39], v[152:155], v[20:23]
v_exp_f32 v173, v125 clamp
v_mfma_f32_16x16x32_bf16 v[32:35], a[40:43], v[152:155], v[32:35]
ds_read_b128 a[24:27], v218 offset:4096
v_cvt_pk_bf16_f32 v146, v172, v173
v_mfma_f32_16x16x32_bf16 v[44:47], a[44:47], v[152:155], v[44:47]
buffer_load_dwordx4 v245, s[20:23], s47 offen offset:3072 nt lds
s_add_u32 s47, s47, 16384
v_mfma_f32_16x16x32_bf16 v[56:59], a[48:51], v[152:155], v[56:59]
ds_read_b128 a[28:31], v219 offset:4096
v_mfma_f32_16x16x32_bf16 v[68:71], a[52:55], v[152:155], v[68:71]
v_exp_f32 v174, v126 clamp
v_mfma_f32_16x16x32_bf16 v[80:83], a[56:59], v[152:155], v[80:83]
v_exp_f32 v175, v127 clamp
v_mfma_f32_16x16x32_bf16 v[92:95], a[60:63], v[152:155], v[92:95]
buffer_load_dword v254, v242, s[36:39], 0 offen
s_waitcnt lgkmcnt(1)
v_cvt_pk_bf16_f32 v147, v174, v175
v_mfma_f32_16x16x32_bf16 v[96:99], a[0:3], a[80:83], v[156:159]
s_waitcnt vmcnt(9)
s_barrier
v_exp_f32 v168, v128 clamp
v_mfma_f32_16x16x32_bf16 v[96:99], a[4:7], a[84:87], v[96:99]
ds_read_b64_tr_b16 a[32:33], v220 offset:49152
ds_read_b64_tr_b16 a[34:35], v220 offset:53248
v_mfma_f32_16x16x32_bf16 v[96:99], a[8:11], a[88:91], v[96:99]
v_exp_f32 v169, v129 clamp
v_mfma_f32_16x16x32_bf16 v[176:179], a[64:67], v[144:147], v[176:179]
ds_read_b64_tr_b16 a[36:37], v221 offset:49152
v_cvt_pk_bf16_f32 v148, v168, v169
v_mfma_f32_16x16x32_bf16 v[96:99], a[12:15], a[92:95], v[96:99]
v_mfma_f32_16x16x32_bf16 v[100:103], a[16:19], a[80:83], v[156:159]
v_exp_f32 v170, v130 clamp
v_mfma_f32_16x16x32_bf16 v[100:103], a[20:23], a[84:87], v[100:103]
s_waitcnt lgkmcnt(3)
ds_read_b64_tr_b16 a[38:39], v221 offset:53248
ds_read_b64_tr_b16 a[40:41], v222 offset:49152
v_mfma_f32_16x16x32_bf16 v[100:103], a[24:27], a[88:91], v[100:103]
v_exp_f32 v171, v131 clamp
v_mfma_f32_16x16x32_bf16 v[100:103], a[28:31], a[92:95], v[100:103]
ds_read_b64_tr_b16 a[42:43], v222 offset:53248
v_cvt_pk_bf16_f32 v149, v170, v171
v_mfma_f32_16x16x32_bf16 v[104:107], a[0:3], a[96:99], v[160:163]
v_exp_f32 v172, v132 clamp
v_mfma_f32_16x16x32_bf16 v[104:107], a[4:7], a[100:103], v[104:107]
v_mfma_f32_16x16x32_bf16 v[104:107], a[8:11], a[104:107], v[104:107]
ds_read_b64_tr_b16 a[44:45], v223 offset:49152
ds_read_b64_tr_b16 a[46:47], v223 offset:53248
v_mfma_f32_16x16x32_bf16 v[104:107], a[12:15], a[108:111], v[104:107]
v_exp_f32 v173, v133 clamp
v_mfma_f32_16x16x32_bf16 v[108:111], a[16:19], a[96:99], v[160:163]
ds_read_b64_tr_b16 a[48:49], v224 offset:49152
v_cvt_pk_bf16_f32 v150, v172, v173
v_mfma_f32_16x16x32_bf16 v[108:111], a[20:23], a[100:103], v[108:111]
v_exp_f32 v174, v134 clamp
v_mfma_f32_16x16x32_bf16 v[108:111], a[24:27], a[104:107], v[108:111]
ds_read_b64_tr_b16 a[50:51], v224 offset:53248
ds_read_b64_tr_b16 a[52:53], v225 offset:49152
v_mfma_f32_16x16x32_bf16 v[108:111], a[28:31], a[108:111], v[108:111]
v_cmp_ngt_f32 vcc, 1.0, v176
v_mfma_f32_16x16x32_bf16 v[112:115], a[0:3], a[112:115], v[164:167]
v_exp_f32 v175, v135 clamp
v_mfma_f32_16x16x32_bf16 v[112:115], a[4:7], a[116:119], v[112:115]
s_cbranch_vccnz L_rs_s11_0
L_rs_s11_0_ret:
ds_read_b64_tr_b16 a[54:55], v225 offset:53248
ds_read_b64_tr_b16 a[56:57], v226 offset:49152
v_mfma_f32_16x16x32_bf16 v[112:115], a[8:11], a[120:123], v[112:115]
ds_read_b64_tr_b16 a[58:59], v226 offset:53248
v_cvt_pk_bf16_f32 v151, v174, v175
v_mfma_f32_16x16x32_bf16 v[112:115], a[12:15], a[124:127], v[112:115]
ds_read_b64_tr_b16 a[60:61], v227 offset:49152
ds_read_b64_tr_b16 a[62:63], v227 offset:53248
v_mfma_f32_16x16x32_bf16 v[116:119], a[16:19], a[112:115], v[164:167]
v_exp_f32 v168, v136 clamp
v_mfma_f32_16x16x32_bf16 v[116:119], a[20:23], a[116:119], v[116:119]
v_mfma_f32_16x16x32_bf16 v[180:183], a[64:67], v[148:151], v[180:183]
v_exp_f32 v169, v137 clamp
v_mfma_f32_16x16x32_bf16 v[116:119], a[24:27], a[120:123], v[116:119]
s_waitcnt lgkmcnt(0)
v_exp_f32 v170, v138 clamp
v_mfma_f32_16x16x32_bf16 v[116:119], a[28:31], a[124:127], v[116:119]
v_exp_f32 v171, v139 clamp
v_mfma_f32_16x16x32_bf16 v[0:3], a[32:35], v[144:147], v[0:3]
ds_read_b128 a[0:3], v216 offset:16384
v_cvt_pk_bf16_f32 v152, v168, v169
v_mfma_f32_16x16x32_bf16 v[12:15], a[36:39], v[144:147], v[12:15]
v_exp_f32 v172, v140 clamp
v_mfma_f32_16x16x32_bf16 v[24:27], a[40:43], v[144:147], v[24:27]
v_cmp_ngt_f32 vcc, 1.0, v180
v_mfma_f32_16x16x32_bf16 v[36:39], a[44:47], v[144:147], v[36:39]
ds_read_b128 a[4:7], v217 offset:16384
v_cvt_pk_bf16_f32 v153, v170, v171
v_mfma_f32_16x16x32_bf16 v[48:51], a[48:51], v[144:147], v[48:51]
s_cbranch_vccnz L_rs_s11_1
L_rs_s11_1_ret:
v_exp_f32 v173, v141 clamp
v_mfma_f32_16x16x32_bf16 v[60:63], a[52:55], v[144:147], v[60:63]
v_exp_f32 v174, v142 clamp
v_mfma_f32_16x16x32_bf16 v[72:75], a[56:59], v[144:147], v[72:75]
ds_read_b128 a[8:11], v218 offset:16384
v_cvt_pk_bf16_f32 v154, v172, v173
v_mfma_f32_16x16x32_bf16 v[84:87], a[60:63], v[144:147], v[84:87]
v_exp_f32 v175, v143 clamp
v_mfma_f32_16x16x32_bf16 v[4:7], a[32:35], v[148:151], v[4:7]
v_mfma_f32_16x16x32_bf16 v[16:19], a[36:39], v[148:151], v[16:19]
ds_read_b128 a[12:15], v219 offset:16384
v_cvt_pk_bf16_f32 v155, v174, v175
v_mfma_f32_16x16x32_bf16 v[28:31], a[40:43], v[148:151], v[28:31]
v_exp_f32 v168, v96 clamp
v_mfma_f32_16x16x32_bf16 v[184:187], a[64:67], v[152:155], v[184:187]
v_exp_f32 v169, v97 clamp
v_mfma_f32_16x16x32_bf16 v[40:43], a[44:47], v[148:151], v[40:43]
ds_read_b128 a[16:19], v216 offset:20480
v_cvt_pk_bf16_f32 v144, v168, v169
v_mfma_f32_16x16x32_bf16 v[52:55], a[48:51], v[148:151], v[52:55]
v_exp_f32 v170, v98 clamp
v_mfma_f32_16x16x32_bf16 v[64:67], a[52:55], v[148:151], v[64:67]
v_mfma_f32_16x16x32_bf16 v[76:79], a[56:59], v[148:151], v[76:79]
v_exp_f32 v171, v99 clamp
v_cmp_ngt_f32 vcc, 1.0, v184
v_mfma_f32_16x16x32_bf16 v[88:91], a[60:63], v[148:151], v[88:91]
s_cbranch_vccnz L_rs_s11_2
L_rs_s11_2_ret:
ds_read_b128 a[20:23], v217 offset:20480
v_cvt_pk_bf16_f32 v145, v170, v171
v_mfma_f32_16x16x32_bf16 v[8:11], a[32:35], v[152:155], v[8:11]
v_exp_f32 v172, v100 clamp
v_mfma_f32_16x16x32_bf16 v[20:23], a[36:39], v[152:155], v[20:23]
v_exp_f32 v173, v101 clamp
v_mfma_f32_16x16x32_bf16 v[32:35], a[40:43], v[152:155], v[32:35]
ds_read_b128 a[24:27], v218 offset:20480
v_cvt_pk_bf16_f32 v146, v172, v173
v_mfma_f32_16x16x32_bf16 v[44:47], a[44:47], v[152:155], v[44:47]
v_mfma_f32_16x16x32_bf16 v[56:59], a[48:51], v[152:155], v[56:59]
ds_read_b128 a[28:31], v219 offset:20480
v_mfma_f32_16x16x32_bf16 v[68:71], a[52:55], v[152:155], v[68:71]
v_exp_f32 v174, v102 clamp
v_mfma_f32_16x16x32_bf16 v[80:83], a[56:59], v[152:155], v[80:83]
v_exp_f32 v175, v103 clamp
v_mfma_f32_16x16x32_bf16 v[92:95], a[60:63], v[152:155], v[92:95]
s_waitcnt lgkmcnt(1)
v_cvt_pk_bf16_f32 v147, v174, v175
v_mfma_f32_16x16x32_bf16 v[120:123], a[0:3], a[80:83], v[156:159]
s_waitcnt vmcnt(5)
s_barrier
v_exp_f32 v168, v104 clamp
v_mfma_f32_16x16x32_bf16 v[120:123], a[4:7], a[84:87], v[120:123]
ds_read_b64_tr_b16 a[32:33], v220 offset:0
ds_read_b64_tr_b16 a[34:35], v220 offset:4096
v_mfma_f32_16x16x32_bf16 v[120:123], a[8:11], a[88:91], v[120:123]
v_exp_f32 v169, v105 clamp
v_mfma_f32_16x16x32_bf16 v[176:179], a[64:67], v[144:147], v[176:179]
ds_read_b64_tr_b16 a[36:37], v221 offset:0
v_cvt_pk_bf16_f32 v148, v168, v169
v_mfma_f32_16x16x32_bf16 v[120:123], a[12:15], a[92:95], v[120:123]
v_mfma_f32_16x16x32_bf16 v[124:127], a[16:19], a[80:83], v[156:159]
v_exp_f32 v170, v106 clamp
v_mfma_f32_16x16x32_bf16 v[124:127], a[20:23], a[84:87], v[124:127]
s_waitcnt lgkmcnt(3)
ds_read_b64_tr_b16 a[38:39], v221 offset:4096
ds_read_b64_tr_b16 a[40:41], v222 offset:0
v_mfma_f32_16x16x32_bf16 v[124:127], a[24:27], a[88:91], v[124:127]
v_exp_f32 v171, v107 clamp
v_mfma_f32_16x16x32_bf16 v[124:127], a[28:31], a[92:95], v[124:127]
ds_read_b64_tr_b16 a[42:43], v222 offset:4096
v_cvt_pk_bf16_f32 v149, v170, v171
v_mfma_f32_16x16x32_bf16 v[128:131], a[0:3], a[96:99], v[160:163]
v_exp_f32 v172, v108 clamp
v_mfma_f32_16x16x32_bf16 v[128:131], a[4:7], a[100:103], v[128:131]
v_mfma_f32_16x16x32_bf16 v[128:131], a[8:11], a[104:107], v[128:131]
ds_read_b64_tr_b16 a[44:45], v223 offset:0
ds_read_b64_tr_b16 a[46:47], v223 offset:4096
v_mfma_f32_16x16x32_bf16 v[128:131], a[12:15], a[108:111], v[128:131]
v_exp_f32 v173, v109 clamp
v_mfma_f32_16x16x32_bf16 v[132:135], a[16:19], a[96:99], v[160:163]
ds_read_b64_tr_b16 a[48:49], v224 offset:0
v_cvt_pk_bf16_f32 v150, v172, v173
v_mfma_f32_16x16x32_bf16 v[132:135], a[20:23], a[100:103], v[132:135]
v_exp_f32 v174, v110 clamp
v_mfma_f32_16x16x32_bf16 v[132:135], a[24:27], a[104:107], v[132:135]
ds_read_b64_tr_b16 a[50:51], v224 offset:4096
ds_read_b64_tr_b16 a[52:53], v225 offset:0
v_mfma_f32_16x16x32_bf16 v[132:135], a[28:31], a[108:111], v[132:135]
v_cmp_ngt_f32 vcc, 1.0, v176
v_mfma_f32_16x16x32_bf16 v[136:139], a[0:3], a[112:115], v[164:167]
v_exp_f32 v175, v111 clamp
v_mfma_f32_16x16x32_bf16 v[136:139], a[4:7], a[116:119], v[136:139]
s_cbranch_vccnz L_rs_s12_0
L_rs_s12_0_ret:
ds_read_b64_tr_b16 a[54:55], v225 offset:4096
ds_read_b64_tr_b16 a[56:57], v226 offset:0
v_mfma_f32_16x16x32_bf16 v[136:139], a[8:11], a[120:123], v[136:139]
ds_read_b64_tr_b16 a[58:59], v226 offset:4096
v_cvt_pk_bf16_f32 v151, v174, v175
v_mfma_f32_16x16x32_bf16 v[136:139], a[12:15], a[124:127], v[136:139]
ds_read_b64_tr_b16 a[60:61], v227 offset:0
ds_read_b64_tr_b16 a[62:63], v227 offset:4096
v_mfma_f32_16x16x32_bf16 v[140:143], a[16:19], a[112:115], v[164:167]
v_exp_f32 v168, v112 clamp
v_mfma_f32_16x16x32_bf16 v[140:143], a[20:23], a[116:119], v[140:143]
v_mfma_f32_16x16x32_bf16 v[180:183], a[64:67], v[148:151], v[180:183]
v_exp_f32 v169, v113 clamp
v_mfma_f32_16x16x32_bf16 v[140:143], a[24:27], a[120:123], v[140:143]
s_waitcnt lgkmcnt(0)
v_exp_f32 v170, v114 clamp
v_mfma_f32_16x16x32_bf16 v[140:143], a[28:31], a[124:127], v[140:143]
v_exp_f32 v171, v115 clamp
v_mfma_f32_16x16x32_bf16 v[0:3], a[32:35], v[144:147], v[0:3]
v_cvt_pk_bf16_f32 v152, v168, v169
v_mfma_f32_16x16x32_bf16 v[12:15], a[36:39], v[144:147], v[12:15]
v_exp_f32 v172, v116 clamp
v_mfma_f32_16x16x32_bf16 v[24:27], a[40:43], v[144:147], v[24:27]
v_cmp_ngt_f32 vcc, 1.0, v180
v_mfma_f32_16x16x32_bf16 v[36:39], a[44:47], v[144:147], v[36:39]
v_cvt_pk_bf16_f32 v153, v170, v171
v_xor_b32 v217, 32, v253
v_mfma_f32_16x16x32_bf16 v[48:51], a[48:51], v[144:147], v[48:51]
s_cbranch_vccnz L_rs_s12_1
L_rs_s12_1_ret:
v_exp_f32 v173, v117 clamp
v_mfma_f32_16x16x32_bf16 v[60:63], a[52:55], v[144:147], v[60:63]
v_exp_f32 v174, v118 clamp
v_mfma_f32_16x16x32_bf16 v[72:75], a[56:59], v[144:147], v[72:75]
v_cvt_pk_bf16_f32 v154, v172, v173
v_xor_b32 v218, 64, v253
v_mfma_f32_16x16x32_bf16 v[84:87], a[60:63], v[144:147], v[84:87]
v_exp_f32 v175, v119 clamp
v_mfma_f32_16x16x32_bf16 v[4:7], a[32:35], v[148:151], v[4:7]
v_mfma_f32_16x16x32_bf16 v[16:19], a[36:39], v[148:151], v[16:19]
v_cvt_pk_bf16_f32 v155, v174, v175
v_mfma_f32_16x16x32_bf16 v[28:31], a[40:43], v[148:151], v[28:31]
v_exp_f32 v168, v120 clamp
v_mfma_f32_16x16x32_bf16 v[184:187], a[64:67], v[152:155], v[184:187]
v_exp_f32 v169, v121 clamp
v_mfma_f32_16x16x32_bf16 v[40:43], a[44:47], v[148:151], v[40:43]
v_cvt_pk_bf16_f32 v144, v168, v169
v_mfma_f32_16x16x32_bf16 v[52:55], a[48:51], v[148:151], v[52:55]
v_exp_f32 v170, v122 clamp
v_mfma_f32_16x16x32_bf16 v[64:67], a[52:55], v[148:151], v[64:67]
v_mfma_f32_16x16x32_bf16 v[76:79], a[56:59], v[148:151], v[76:79]
v_exp_f32 v171, v123 clamp
v_cmp_ngt_f32 vcc, 1.0, v184
v_mfma_f32_16x16x32_bf16 v[88:91], a[60:63], v[148:151], v[88:91]
buffer_load_dwordx4 v[188:191], v241, s[32:35], s92 offen offset:0 sc1
s_cbranch_vccnz L_rs_s12_2
L_rs_s12_2_ret:
v_cvt_pk_bf16_f32 v145, v170, v171
v_mfma_f32_16x16x32_bf16 v[8:11], a[32:35], v[152:155], v[8:11]
v_exp_f32 v172, v124 clamp
v_mfma_f32_16x16x32_bf16 v[20:23], a[36:39], v[152:155], v[20:23]
buffer_load_dwordx4 v[192:195], v241, s[32:35], s92 offen offset:1024 sc1
v_exp_f32 v173, v125 clamp
v_mfma_f32_16x16x32_bf16 v[32:35], a[40:43], v[152:155], v[32:35]
v_cvt_pk_bf16_f32 v146, v172, v173
v_mfma_f32_16x16x32_bf16 v[44:47], a[44:47], v[152:155], v[44:47]
buffer_load_dwordx4 v[196:199], v241, s[32:35], s92 offen offset:2048 sc1
v_mfma_f32_16x16x32_bf16 v[56:59], a[48:51], v[152:155], v[56:59]
v_xor_b32 v219, 96, v253
v_mfma_f32_16x16x32_bf16 v[68:71], a[52:55], v[152:155], v[68:71]
buffer_load_dwordx4 v[200:203], v241, s[32:35], s92 offen offset:3072 sc1
v_exp_f32 v174, v126 clamp
v_mfma_f32_16x16x32_bf16 v[80:83], a[56:59], v[152:155], v[80:83]
v_exp_f32 v175, v127 clamp
v_mfma_f32_16x16x32_bf16 v[92:95], a[60:63], v[152:155], v[92:95]
buffer_load_dwordx4 v[204:207], v241, s[32:35], s93 offen offset:0 sc1
v_cvt_pk_bf16_f32 v147, v174, v175
s_waitcnt vmcnt(5)
s_barrier
v_mfma_f32_16x16x32_bf16 v[176:179], a[64:67], v[144:147], v[176:179]
ds_read_b64_tr_b16 a[48:49], v224 offset:16384
ds_read_b64_tr_b16 a[50:51], v224 offset:20480
ds_read_b64_tr_b16 a[52:53], v225 offset:16384
ds_read_b64_tr_b16 a[54:55], v225 offset:20480
ds_read_b64_tr_b16 a[56:57], v226 offset:16384
ds_read_b64_tr_b16 a[58:59], v226 offset:20480
ds_read_b64_tr_b16 a[60:61], v227 offset:16384
ds_read_b64_tr_b16 a[62:63], v227 offset:20480
ds_read_b64_tr_b16 a[32:33], v220 offset:16384
ds_read_b64_tr_b16 a[34:35], v220 offset:20480
ds_read_b64_tr_b16 a[36:37], v221 offset:16384
ds_read_b64_tr_b16 a[38:39], v221 offset:20480
ds_read_b64_tr_b16 a[40:41], v222 offset:16384
ds_read_b64_tr_b16 a[42:43], v222 offset:20480
ds_read_b64_tr_b16 a[44:45], v223 offset:16384
ds_read_b64_tr_b16 a[46:47], v223 offset:20480
buffer_load_dwordx4 v[208:211], v241, s[32:35], s93 offen offset:1024 sc1
buffer_load_dwordx2 v[212:213], v228, s[32:35], s93 offen offset:2048 sc1
v_cmp_eq_u32 vcc, 0, v254
v_exp_f32 v168, v128 clamp
v_exp_f32 v169, v129 clamp
s_cbranch_vccnz L_nonwait
L_havenon:
v_cmp_ngt_f32 vcc, 1.0, v176
v_exp_f32 v170, v130 clamp
v_exp_f32 v171, v131 clamp
s_cbranch_vccnz L_rs_l_0
L_rs_l_0_ret:
s_waitcnt lgkmcnt(8)
v_mfma_f32_16x16x32_bf16 v[48:51], a[48:51], v[144:147], v[48:51]
v_exp_f32 v172, v132 clamp
v_exp_f32 v173, v133 clamp
v_mfma_f32_16x16x32_bf16 v[60:63], a[52:55], v[144:147], v[60:63]
v_exp_f32 v174, v134 clamp
v_exp_f32 v175, v135 clamp
v_mfma_f32_16x16x32_bf16 v[72:75], a[56:59], v[144:147], v[72:75]
v_cvt_pk_bf16_f32 v148, v168, v169
v_cvt_pk_bf16_f32 v149, v170, v171
v_mfma_f32_16x16x32_bf16 v[84:87], a[60:63], v[144:147], v[84:87]
v_cvt_pk_bf16_f32 v150, v172, v173
v_cvt_pk_bf16_f32 v151, v174, v175
s_waitcnt lgkmcnt(0)
v_mfma_f32_16x16x32_bf16 v[0:3], a[32:35], v[144:147], v[0:3]
v_exp_f32 v168, v136 clamp
v_exp_f32 v169, v137 clamp
v_mfma_f32_16x16x32_bf16 v[180:183], a[64:67], v[148:151], v[180:183]
v_exp_f32 v170, v138 clamp
v_exp_f32 v171, v139 clamp
v_mfma_f32_16x16x32_bf16 v[12:15], a[36:39], v[144:147], v[12:15]
v_exp_f32 v172, v140 clamp
v_exp_f32 v173, v141 clamp
v_mfma_f32_16x16x32_bf16 v[24:27], a[40:43], v[144:147], v[24:27]
v_exp_f32 v174, v142 clamp
v_exp_f32 v175, v143 clamp
v_mfma_f32_16x16x32_bf16 v[36:39], a[44:47], v[144:147], v[36:39]
v_cmp_ngt_f32 vcc, 1.0, v180
v_cvt_pk_bf16_f32 v152, v168, v169
v_cvt_pk_bf16_f32 v153, v170, v171
s_cbranch_vccnz L_rs_l_1
L_rs_l_1_ret:
v_mfma_f32_16x16x32_bf16 v[52:55], a[48:51], v[148:151], v[52:55]
v_cvt_pk_bf16_f32 v154, v172, v173
v_cvt_pk_bf16_f32 v155, v174, v175
v_mfma_f32_16x16x32_bf16 v[64:67], a[52:55], v[148:151], v[64:67]
s_nop 0
v_mfma_f32_16x16x32_bf16 v[184:187], a[64:67], v[152:155], v[184:187]
v_mfma_f32_16x16x32_bf16 v[76:79], a[56:59], v[148:151], v[76:79]
v_cvt_pk_bf16_f32 v48, v48, v49
v_cvt_pk_bf16_f32 v49, v50, v51
v_cvt_pk_bf16_f32 v50, v60, v61
v_mfma_f32_16x16x32_bf16 v[88:91], a[60:63], v[148:151], v[88:91]
v_cvt_pk_bf16_f32 v51, v62, v63
ds_write_b128 v251, v[48:51] offset:0
v_cvt_pk_bf16_f32 v72, v72, v73
v_mfma_f32_16x16x32_bf16 v[4:7], a[32:35], v[148:151], v[4:7]
v_cvt_pk_bf16_f32 v73, v74, v75
v_cvt_pk_bf16_f32 v74, v84, v85
v_cvt_pk_bf16_f32 v75, v86, v87
v_mfma_f32_16x16x32_bf16 v[16:19], a[36:39], v[148:151], v[16:19]
ds_write_b128 v251, v[72:75] offset:1024
v_cmp_ngt_f32 vcc, 1.0, v184
v_cmp_eq_u32 s[60:61], 1, v246
v_cmp_eq_u32 s[62:63], 2, v246
s_cbranch_vccnz L_rs_l_2
L_rs_l_2_ret:
v_mfma_f32_16x16x32_bf16 v[56:59], a[48:51], v[152:155], v[56:59]
v_cvt_pk_bf16_f32 v52, v52, v53
v_cvt_pk_bf16_f32 v53, v54, v55
v_cvt_pk_bf16_f32 v54, v64, v65
v_cvt_pk_bf16_f32 v55, v66, v67
v_mfma_f32_16x16x32_bf16 v[68:71], a[52:55], v[152:155], v[68:71]
ds_write_b128 v251, v[52:55] offset:2048
v_cvt_pk_bf16_f32 v76, v76, v77
v_cvt_pk_bf16_f32 v77, v78, v79
v_cvt_pk_bf16_f32 v78, v88, v89
v_mfma_f32_16x16x32_bf16 v[80:83], a[56:59], v[152:155], v[80:83]
v_cvt_pk_bf16_f32 v79, v90, v91
ds_write_b128 v251, v[76:79] offset:3072
v_cmp_eq_u32 s[64:65], 3, v246
v_mov_b32 v235, s50
v_mfma_f32_16x16x32_bf16 v[92:95], a[60:63], v[152:155], v[92:95]
v_mov_b32 v97, v156
v_mov_b32 v98, v160
v_mov_b32 v99, v164
v_cndmask_b32 v96, v176, v180, s[60:61]
v_cndmask_b32 v96, v96, v184, s[62:63]
v_cndmask_b32 v96, v96, v235, s[64:65]
ds_write_b128 v251, v[96:99] offset:6144
s_cmp_eq_u32 s41, 0
s_cbranch_scc1 L_plain
v_mfma_f32_16x16x32_bf16 v[28:31], a[40:43], v[148:151], v[28:31]
v_cvt_pk_bf16_f32 v56, v56, v57
v_cvt_pk_bf16_f32 v57, v58, v59
v_cvt_pk_bf16_f32 v58, v68, v69
v_cvt_pk_bf16_f32 v59, v70, v71
v_mfma_f32_16x16x32_bf16 v[40:43], a[44:47], v[148:151], v[40:43]
ds_write_b128 v251, v[56:59] offset:4096
v_cvt_pk_bf16_f32 v80, v80, v81
v_cvt_pk_bf16_f32 v81, v82, v83
v_cvt_pk_bf16_f32 v82, v92, v93
v_mfma_f32_16x16x32_bf16 v[8:11], a[32:35], v[152:155], v[8:11]
v_cvt_pk_bf16_f32 v83, v94, v95
ds_write_b128 v251, v[80:83] offset:5120
s_waitcnt vmcnt(0)
v_mfma_f32_16x16x32_bf16 v[20:23], a[36:39], v[152:155], v[20:23]
v_add3_u32 v230, v254, v212, v188
v_add3_u32 v231, v189, v190, v191
v_add3_u32 v230, v230, v192, v193
v_add3_u32 v231, v231, v194, v195
v_add3_u32 v230, v230, v196, v197
v_mfma_f32_16x16x32_bf16 v[32:35], a[40:43], v[152:155], v[32:35]
v_add3_u32 v231, v231, v198, v199
v_add3_u32 v230, v230, v200, v201
v_add3_u32 v231, v231, v202, v203
v_add3_u32 v230, v230, v204, v205
v_add3_u32 v231, v231, v206, v207
v_mfma_f32_16x16x32_bf16 v[44:47], a[44:47], v[152:155], v[44:47]
v_add3_u32 v230, v230, v208, v209
v_add3_u32 v231, v231, v210, v211
v_add_u32 v230, v230, v231
v_cmp_ne_u32 vcc, v230, v213
v_readlane_b32 s66, v212, 63
s_waitcnt lgkmcnt(0)
s_and_b32 s67, s66, 1
s_or_b32 s67, s67, s50
s_or_b32 s67, s67, vcc_lo
s_or_b32 s67, s67, vcc_hi
s_cbranch_scc1 L_plain2
s_waitcnt lgkmcnt(0)
s_barrier
ds_read_b128 v[100:103], v229 offset:6144
ds_read_b128 a[0:3], v229 offset:0
ds_read_b128 a[4:7], v229 offset:1024
ds_read_b128 a[8:11], v229 offset:2048
ds_read_b128 a[12:15], v229 offset:3072
ds_read_b128 a[16:19], v229 offset:4096
ds_read_b128 a[20:23], v229 offset:5120
v_add_f32 v236, v96, v212
v_mfma_f32_16x16x32_bf16 v[0:3], a[72:75], v[188:191], v[0:3]
v_mfma_f32_16x16x32_bf16 v[12:15], a[76:79], v[188:191], v[12:15]
v_mfma_f32_16x16x32_bf16 v[24:27], a[72:75], v[192:195], v[24:27]
v_mfma_f32_16x16x32_bf16 v[36:39], a[76:79], v[192:195], v[36:39]
v_mfma_f32_16x16x32_bf16 v[4:7], a[72:75], v[196:199], v[4:7]
v_mfma_f32_16x16x32_bf16 v[16:19], a[76:79], v[196:199], v[16:19]
s_waitcnt lgkmcnt(6)
v_readlane_b32 s66, v100, 63
v_add_f32 v237, v236, v100
v_mfma_f32_16x16x32_bf16 v[28:31], a[72:75], v[200:203], v[28:31]
v_mfma_f32_16x16x32_bf16 v[40:43], a[76:79], v[200:203], v[40:43]
s_cmp_lg_u32 s66, 0
s_cbranch_scc1 L_slow3
v_rcp_f32 v236, v237
s_waitcnt lgkmcnt(0)
v_mfma_f32_16x16x32_bf16 v[0:3], a[72:75], a[0:3], v[0:3]
v_mov_b32 v237, v236
s_nop 0
v_mfma_f32_16x16x32_bf16 v[12:15], a[76:79], a[0:3], v[12:15]
v_permlane16_swap_b32 v236, v237
s_nop 0
v_mfma_f32_16x16x32_bf16 v[24:27], a[72:75], a[4:7], v[24:27]
v_mov_b32 v238, v236
v_mov_b32 v239, v237
v_mfma_f32_16x16x32_bf16 v[36:39], a[76:79], a[4:7], v[36:39]
s_nop 0
v_permlane32_swap_b32 v236, v238
v_mfma_f32_16x16x32_bf16 v[8:11], a[72:75], v[204:207], v[8:11]
v_permlane32_swap_b32 v237, v239
s_add_u32 s66, s44, 4096
v_mfma_f32_16x16x32_bf16 v[20:23], a[76:79], v[204:207], v[20:23]
s_add_u32 s67, s44, 8192
v_mfma_f32_16x16x32_bf16 v[32:35], a[72:75], v[208:211], v[32:35]
v_mfma_f32_16x16x32_bf16 v[44:47], a[76:79], v[208:211], v[44:47]
v_mfma_f32_16x16x32_bf16 v[4:7], a[72:75], a[8:11], v[4:7]
v_pk_mul_f32 v[0:1], v[0:1], v[236:237] op_sel:[0,0] op_sel_hi:[1,0]
v_pk_mul_f32 v[2:3], v[2:3], v[236:237] op_sel:[0,0] op_sel_hi:[1,0]
v_cvt_pk_bf16_f32 v0, v0, v1
v_mfma_f32_16x16x32_bf16 v[16:19], a[76:79], a[8:11], v[16:19]
v_cvt_pk_bf16_f32 v1, v2, v3
ds_write_b64 v253, v[0:1] offset:0
v_pk_mul_f32 v[12:13], v[12:13], v[236:237] op_sel:[0,0] op_sel_hi:[1,0]
v_mfma_f32_16x16x32_bf16 v[28:31], a[72:75], a[12:15], v[28:31]
v_pk_mul_f32 v[14:15], v[14:15], v[236:237] op_sel:[0,0] op_sel_hi:[1,0]
v_cvt_pk_bf16_f32 v12, v12, v13
v_cvt_pk_bf16_f32 v13, v14, v15
v_mfma_f32_16x16x32_bf16 v[40:43], a[76:79], a[12:15], v[40:43]
ds_write_b64 v217, v[12:13] offset:0
v_pk_mul_f32 v[24:25], v[24:25], v[236:237] op_sel:[0,0] op_sel_hi:[1,0]
v_pk_mul_f32 v[26:27], v[26:27], v[236:237] op_sel:[0,0] op_sel_hi:[1,0]
v_mfma_f32_16x16x32_bf16 v[8:11], a[72:75], a[16:19], v[8:11]
v_cvt_pk_bf16_f32 v24, v24, v25
v_cvt_pk_bf16_f32 v25, v26, v27
ds_write_b64 v218, v[24:25] offset:0
v_mfma_f32_16x16x32_bf16 v[20:23], a[76:79], a[16:19], v[20:23]
v_pk_mul_f32 v[36:37], v[36:37], v[236:237] op_sel:[0,0] op_sel_hi:[1,0]
v_pk_mul_f32 v[38:39], v[38:39], v[236:237] op_sel:[0,0] op_sel_hi:[1,0]
v_cvt_pk_bf16_f32 v36, v36, v37
v_mfma_f32_16x16x32_bf16 v[32:35], a[72:75], a[20:23], v[32:35]
v_cvt_pk_bf16_f32 v37, v38, v39
ds_write_b64 v219, v[36:37] offset:0
ds_read_b128 v[120:123], v252 offset:0
v_mfma_f32_16x16x32_bf16 v[44:47], a[76:79], a[20:23], v[44:47]
ds_read_b128 v[124:127], v252 offset:1024
L_out12:
v_pk_mul_f32 v[4:5], v[4:5], v[236:237] op_sel:[0,1] op_sel_hi:[1,1]
v_pk_mul_f32 v[6:7], v[6:7], v[236:237] op_sel:[0,1] op_sel_hi:[1,1]
v_cvt_pk_bf16_f32 v4, v4, v5
v_cvt_pk_bf16_f32 v5, v6, v7
ds_write_b64 v253, v[4:5] offset:2048
v_pk_mul_f32 v[16:17], v[16:17], v[236:237] op_sel:[0,1] op_sel_hi:[1,1]
v_pk_mul_f32 v[18:19], v[18:19], v[236:237] op_sel:[0,1] op_sel_hi:[1,1]
v_cvt_pk_bf16_f32 v16, v16, v17
v_cvt_pk_bf16_f32 v17, v18, v19
ds_write_b64 v217, v[16:17] offset:2048
v_pk_mul_f32 v[28:29], v[28:29], v[236:237] op_sel:[0,1] op_sel_hi:[1,1]
v_pk_mul_f32 v[30:31], v[30:31], v[236:237] op_sel:[0,1] op_sel_hi:[1,1]
v_cvt_pk_bf16_f32 v28, v28, v29
v_cvt_pk_bf16_f32 v29, v30, v31
ds_write_b64 v218, v[28:29] offset:2048
v_pk_mul_f32 v[40:41], v[40:41], v[236:237] op_sel:[0,1] op_sel_hi:[1,1]
v_pk_mul_f32 v[42:43], v[42:43], v[236:237] op_sel:[0,1] op_sel_hi:[1,1]
v_cvt_pk_bf16_f32 v40, v40, v41
v_cvt_pk_bf16_f32 v41, v42, v43
ds_write_b64 v219, v[40:41] offset:2048
ds_read_b128 v[128:131], v252 offset:2048
ds_read_b128 v[132:135], v252 offset:3072
s_waitcnt lgkmcnt(6)
buffer_store_dwordx4 v[120:123], v243, s[28:31], s44 offen offset:0 sc1
buffer_store_dwordx4 v[124:127], v243, s[28:31], s44 offen offset:2048 sc1
v_pk_mul_f32 v[8:9], v[8:9], v[238:239] op_sel:[0,0] op_sel_hi:[1,0]
v_pk_mul_f32 v[10:11], v[10:11], v[238:239] op_sel:[0,0] op_sel_hi:[1,0]
v_cvt_pk_bf16_f32 v8, v8, v9
v_cvt_pk_bf16_f32 v9, v10, v11
ds_write_b64 v253, v[8:9] offset:4096
v_pk_mul_f32 v[20:21], v[20:21], v[238:239] op_sel:[0,0] op_sel_hi:[1,0]
v_pk_mul_f32 v[22:23], v[22:23], v[238:239] op_sel:[0,0] op_sel_hi:[1,0]
v_cvt_pk_bf16_f32 v20, v20, v21
v_cvt_pk_bf16_f32 v21, v22, v23
ds_write_b64 v217, v[20:21] offset:4096
v_pk_mul_f32 v[32:33], v[32:33], v[238:239] op_sel:[0,0] op_sel_hi:[1,0]
v_pk_mul_f32 v[34:35], v[34:35], v[238:239] op_sel:[0,0] op_sel_hi:[1,0]
v_cvt_pk_bf16_f32 v32, v32, v33
v_cvt_pk_bf16_f32 v33, v34, v35
ds_write_b64 v218, v[32:33] offset:4096
v_pk_mul_f32 v[44:45], v[44:45], v[238:239] op_sel:[0,0] op_sel_hi:[1,0]
v_pk_mul_f32 v[46:47], v[46:47], v[238:239] op_sel:[0,0] op_sel_hi:[1,0]
v_cvt_pk_bf16_f32 v44, v44, v45
v_cvt_pk_bf16_f32 v45, v46, v47
ds_write_b64 v219, v[44:45] offset:4096
ds_read_b128 v[136:139], v252 offset:4096
ds_read_b128 v[140:143], v252 offset:5120
s_waitcnt lgkmcnt(6)
buffer_store_dwordx4 v[128:131], v243, s[28:31], s66 offen offset:0 sc1
buffer_store_dwordx4 v[132:135], v243, s[28:31], s66 offen offset:2048 sc1
s_waitcnt lgkmcnt(0)
buffer_store_dwordx4 v[136:139], v243, s[28:31], s67 offen offset:0 sc1
buffer_store_dwordx4 v[140:143], v243, s[28:31], s67 offen offset:2048 sc1
s_branch L_fin
L_plain:
v_mfma_f32_16x16x32_bf16 v[28:31], a[40:43], v[148:151], v[28:31]
v_cvt_pk_bf16_f32 v56, v56, v57
v_cvt_pk_bf16_f32 v57, v58, v59
v_cvt_pk_bf16_f32 v58, v68, v69
v_cvt_pk_bf16_f32 v59, v70, v71
v_mfma_f32_16x16x32_bf16 v[40:43], a[44:47], v[148:151], v[40:43]
ds_write_b128 v251, v[56:59] offset:4096
v_cvt_pk_bf16_f32 v80, v80, v81
v_cvt_pk_bf16_f32 v81, v82, v83
v_cvt_pk_bf16_f32 v82, v92, v93
v_mfma_f32_16x16x32_bf16 v[8:11], a[32:35], v[152:155], v[8:11]
v_cvt_pk_bf16_f32 v83, v94, v95
ds_write_b128 v251, v[80:83] offset:5120
s_waitcnt lgkmcnt(0)
s_barrier
ds_read_b128 v[100:103], v229 offset:6144
ds_read_b128 a[0:3], v229 offset:0
ds_read_b128 a[4:7], v229 offset:1024
ds_read_b128 a[8:11], v229 offset:2048
ds_read_b128 a[12:15], v229 offset:3072
ds_read_b128 a[16:19], v229 offset:4096
ds_read_b128 a[20:23], v229 offset:5120
v_mfma_f32_16x16x32_bf16 v[20:23], a[36:39], v[152:155], v[20:23]
v_mfma_f32_16x16x32_bf16 v[32:35], a[40:43], v[152:155], v[32:35]
v_mfma_f32_16x16x32_bf16 v[44:47], a[44:47], v[152:155], v[44:47]
L_plain3:
s_waitcnt lgkmcnt(6)
v_or_b32 v232, v96, v100
v_add_f32 v236, v96, v100
v_readlane_b32 s66, v232, 63
s_waitcnt lgkmcnt(0)
s_cmp_lg_u32 s66, 0
s_cbranch_scc1 L_slow1
s_cmp_lg_u32 s41, 0
s_cbranch_scc1 L_roleB
v_mfma_f32_16x16x32_bf16 v[0:3], a[72:75], a[0:3], v[0:3]
v_or_b32 v235, s50, v254
v_mfma_f32_16x16x32_bf16 v[12:15], a[76:79], a[0:3], v[12:15]
v_cndmask_b32 v96, v236, v235, s[64:65]
v_mfma_f32_16x16x32_bf16 v[24:27], a[72:75], a[4:7], v[24:27]
v_add_u32 v97, v96, v254
v_mfma_f32_16x16x32_bf16 v[36:39], a[76:79], a[4:7], v[36:39]
v_mfma_f32_16x16x32_bf16 v[4:7], a[72:75], a[8:11], v[4:7]
v_mfma_f32_16x16x32_bf16 v[16:19], a[76:79], a[8:11], v[16:19]
v_mfma_f32_16x16x32_bf16 v[28:31], a[72:75], a[12:15], v[28:31]
v_cvt_pk_bf16_f32 v0, v0, v1
v_cvt_pk_bf16_f32 v1, v2, v3
v_cvt_pk_bf16_f32 v2, v12, v13
v_mfma_f32_16x16x32_bf16 v[40:43], a[76:79], a[12:15], v[40:43]
v_cvt_pk_bf16_f32 v3, v14, v15
buffer_store_dwordx4 v[0:3], v241, s[32:35], s70 offen offset:0 sc1
v_add3_u32 v97, v97, v0, v1
v_mfma_f32_16x16x32_bf16 v[8:11], a[72:75], a[16:19], v[8:11]
v_add3_u32 v97, v97, v2, v3
v_cvt_pk_bf16_f32 v24, v24, v25
v_cvt_pk_bf16_f32 v25, v26, v27
v_mfma_f32_16x16x32_bf16 v[20:23], a[76:79], a[16:19], v[20:23]
v_cvt_pk_bf16_f32 v26, v36, v37
v_cvt_pk_bf16_f32 v27, v38, v39
buffer_store_dwordx4 v[24:27], v241, s[32:35], s70 offen offset:1024 sc1
v_mfma_f32_16x16x32_bf16 v[32:35], a[72:75], a[20:23], v[32:35]
v_add3_u32 v97, v97, v24, v25
v_add3_u32 v97, v97, v26, v27
v_mfma_f32_16x16x32_bf16 v[44:47], a[76:79], a[20:23], v[44:47]
L_pub12:
v_cvt_pk_bf16_f32 v4, v4, v5
v_cvt_pk_bf16_f32 v5, v6, v7
v_cvt_pk_bf16_f32 v6, v16, v17
v_cvt_pk_bf16_f32 v7, v18, v19
buffer_store_dwordx4 v[4:7], v241, s[32:35], s70 offen offset:2048 sc1
v_add3_u32 v97, v97, v4, v5
v_add3_u32 v97, v97, v6, v7
v_cvt_pk_bf16_f32 v28, v28, v29
v_cvt_pk_bf16_f32 v29, v30, v31
v_cvt_pk_bf16_f32 v30, v40, v41
v_cvt_pk_bf16_f32 v31, v42, v43
buffer_store_dwordx4 v[28:31], v241, s[32:35], s70 offen offset:3072 sc1
v_add3_u32 v97, v97, v28, v29
v_add3_u32 v97, v97, v30, v31
v_cvt_pk_bf16_f32 v8, v8, v9
v_cvt_pk_bf16_f32 v9, v10, v11
v_cvt_pk_bf16_f32 v10, v20, v21
v_cvt_pk_bf16_f32 v11, v22, v23
buffer_store_dwordx4 v[8:11], v241, s[32:35], s80 offen offset:0 sc1
v_add3_u32 v97, v97, v8, v9
v_add3_u32 v97, v97, v10, v11
v_cvt_pk_bf16_f32 v32, v32, v33
v_cvt_pk_bf16_f32 v33, v34, v35
v_cvt_pk_bf16_f32 v34, v44, v45
v_cvt_pk_bf16_f32 v35, v46, v47
buffer_store_dwordx4 v[32:35], v241, s[32:35], s80 offen offset:1024 sc1
v_add3_u32 v97, v97, v32, v33
v_add3_u32 v97, v97, v34, v35
buffer_store_dwordx2 v[96:97], v228, s[32:35], s80 offen offset:2048 sc1
L_fin:
L_end:
s_endpgm
L_firstA:
v_mfma_f32_16x16x32_bf16 v[120:123], a[0:3], a[80:83], v[156:159]
s_waitcnt vmcnt(4)
s_barrier
v_exp_f32 v168, v104 clamp
v_mfma_f32_16x16x32_bf16 v[120:123], a[4:7], a[84:87], v[120:123]
ds_read_b64_tr_b16 a[32:33], v220 offset:0
ds_read_b64_tr_b16 a[34:35], v220 offset:4096
v_mfma_f32_16x16x32_bf16 v[120:123], a[8:11], a[88:91], v[120:123]
s_add_u32 m0, s43, 49152
v_exp_f32 v169, v105 clamp
v_mfma_f32_16x16x32_bf16 v[176:179], a[64:67], v[144:147], 0
buffer_load_dwordx4 v244, s[16:19], s46 offen offset:0 nt lds
ds_read_b64_tr_b16 a[36:37], v221 offset:0
v_cvt_pk_bf16_f32 v148, v168, v169
v_mfma_f32_16x16x32_bf16 v[120:123], a[12:15], a[92:95], v[120:123]
v_mfma_f32_16x16x32_bf16 v[124:127], a[16:19], a[80:83], v[156:159]
v_exp_f32 v170, v106 clamp
v_mfma_f32_16x16x32_bf16 v[124:127], a[20:23], a[84:87], v[124:127]
buffer_load_dwordx4 v245, s[16:19], s46 offen offset:1024 nt lds
s_waitcnt lgkmcnt(3)
ds_read_b64_tr_b16 a[38:39], v221 offset:4096
ds_read_b64_tr_b16 a[40:41], v222 offset:0
v_mfma_f32_16x16x32_bf16 v[124:127], a[24:27], a[88:91], v[124:127]
v_exp_f32 v171, v107 clamp
v_mfma_f32_16x16x32_bf16 v[124:127], a[28:31], a[92:95], v[124:127]
ds_read_b64_tr_b16 a[42:43], v222 offset:4096
v_cvt_pk_bf16_f32 v149, v170, v171
v_mfma_f32_16x16x32_bf16 v[128:131], a[0:3], a[96:99], v[160:163]
buffer_load_dwordx4 v244, s[16:19], s46 offen offset:2048 nt lds
v_exp_f32 v172, v108 clamp
v_mfma_f32_16x16x32_bf16 v[128:131], a[4:7], a[100:103], v[128:131]
v_mfma_f32_16x16x32_bf16 v[128:131], a[8:11], a[104:107], v[128:131]
ds_read_b64_tr_b16 a[44:45], v223 offset:0
ds_read_b64_tr_b16 a[46:47], v223 offset:4096
v_mfma_f32_16x16x32_bf16 v[128:131], a[12:15], a[108:111], v[128:131]
buffer_load_dwordx4 v245, s[16:19], s46 offen offset:3072 nt lds
s_add_u32 s46, s46, 16384
v_exp_f32 v173, v109 clamp
v_mfma_f32_16x16x32_bf16 v[132:135], a[16:19], a[96:99], v[160:163]
ds_read_b64_tr_b16 a[48:49], v224 offset:0
v_cvt_pk_bf16_f32 v150, v172, v173
v_mfma_f32_16x16x32_bf16 v[132:135], a[20:23], a[100:103], v[132:135]
s_add_u32 m0, s43, 81920
v_exp_f32 v174, v110 clamp
v_mfma_f32_16x16x32_bf16 v[132:135], a[24:27], a[104:107], v[132:135]
buffer_load_dwordx4 v244, s[20:23], s47 offen offset:0 nt lds
ds_read_b64_tr_b16 a[50:51], v224 offset:4096
ds_read_b64_tr_b16 a[52:53], v225 offset:0
v_mfma_f32_16x16x32_bf16 v[132:135], a[28:31], a[108:111], v[132:135]
v_cmp_ngt_f32 vcc, 1.0, v176
v_mfma_f32_16x16x32_bf16 v[136:139], a[0:3], a[112:115], v[164:167]
v_exp_f32 v175, v111 clamp
v_mfma_f32_16x16x32_bf16 v[136:139], a[4:7], a[116:119], v[136:139]
buffer_load_dwordx4 v245, s[20:23], s47 offen offset:1024 nt lds
s_cbranch_vccnz L_rs_sa0_0
L_rs_sa0_0_ret:
ds_read_b64_tr_b16 a[54:55], v225 offset:4096
ds_read_b64_tr_b16 a[56:57], v226 offset:0
v_mfma_f32_16x16x32_bf16 v[136:139], a[8:11], a[120:123], v[136:139]
ds_read_b64_tr_b16 a[58:59], v226 offset:4096
v_cvt_pk_bf16_f32 v151, v174, v175
v_mfma_f32_16x16x32_bf16 v[136:139], a[12:15], a[124:127], v[136:139]
ds_read_b64_tr_b16 a[60:61], v227 offset:0
ds_read_b64_tr_b16 a[62:63], v227 offset:4096
v_mfma_f32_16x16x32_bf16 v[140:143], a[16:19], a[112:115], v[164:167]
buffer_load_dwordx4 v244, s[20:23], s47 offen offset:2048 nt lds
v_exp_f32 v168, v112 clamp
v_mfma_f32_16x16x32_bf16 v[140:143], a[20:23], a[116:119], v[140:143]
v_mfma_f32_16x16x32_bf16 v[180:183], a[64:67], v[148:151], 0
v_exp_f32 v169, v113 clamp
v_mfma_f32_16x16x32_bf16 v[140:143], a[24:27], a[120:123], v[140:143]
buffer_load_dwordx4 v245, s[20:23], s47 offen offset:3072 nt lds
s_waitcnt lgkmcnt(0)
s_add_u32 s47, s47, 16384
v_exp_f32 v170, v114 clamp
v_mfma_f32_16x16x32_bf16 v[140:143], a[28:31], a[124:127], v[140:143]
s_waitcnt vmcnt(8)
s_barrier
v_exp_f32 v171, v115 clamp
v_mfma_f32_16x16x32_bf16 v[0:3], a[32:35], v[144:147], 0
ds_read_b128 a[0:3], v216 offset:32768
v_cvt_pk_bf16_f32 v152, v168, v169
v_mfma_f32_16x16x32_bf16 v[12:15], a[36:39], v[144:147], 0
v_exp_f32 v172, v116 clamp
v_mfma_f32_16x16x32_bf16 v[24:27], a[40:43], v[144:147], 0
v_cmp_ngt_f32 vcc, 1.0, v180
v_mfma_f32_16x16x32_bf16 v[36:39], a[44:47], v[144:147], 0
ds_read_b128 a[4:7], v217 offset:32768
v_cvt_pk_bf16_f32 v153, v170, v171
v_mfma_f32_16x16x32_bf16 v[48:51], a[48:51], v[144:147], 0
s_cbranch_vccnz L_rs_sa0_1
L_rs_sa0_1_ret:
v_exp_f32 v173, v117 clamp
v_mfma_f32_16x16x32_bf16 v[60:63], a[52:55], v[144:147], 0
v_exp_f32 v174, v118 clamp
v_mfma_f32_16x16x32_bf16 v[72:75], a[56:59], v[144:147], 0
ds_read_b128 a[8:11], v218 offset:32768
v_cvt_pk_bf16_f32 v154, v172, v173
v_mfma_f32_16x16x32_bf16 v[84:87], a[60:63], v[144:147], 0
v_exp_f32 v175, v119 clamp
v_mfma_f32_16x16x32_bf16 v[4:7], a[32:35], v[148:151], 0
v_mfma_f32_16x16x32_bf16 v[16:19], a[36:39], v[148:151], 0
ds_read_b128 a[12:15], v219 offset:32768
v_cvt_pk_bf16_f32 v155, v174, v175
v_mfma_f32_16x16x32_bf16 v[28:31], a[40:43], v[148:151], 0
v_exp_f32 v168, v120 clamp
v_mfma_f32_16x16x32_bf16 v[184:187], a[64:67], v[152:155], 0
v_exp_f32 v169, v121 clamp
v_mfma_f32_16x16x32_bf16 v[40:43], a[44:47], v[148:151], 0
ds_read_b128 a[16:19], v216 offset:36864
v_cvt_pk_bf16_f32 v144, v168, v169
v_mfma_f32_16x16x32_bf16 v[52:55], a[48:51], v[148:151], 0
v_exp_f32 v170, v122 clamp
v_mfma_f32_16x16x32_bf16 v[64:67], a[52:55], v[148:151], 0
v_mfma_f32_16x16x32_bf16 v[76:79], a[56:59], v[148:151], 0
v_exp_f32 v171, v123 clamp
v_cmp_ngt_f32 vcc, 1.0, v184
v_mfma_f32_16x16x32_bf16 v[88:91], a[60:63], v[148:151], 0
s_cbranch_vccnz L_rs_sa0_2
L_rs_sa0_2_ret:
ds_read_b128 a[20:23], v217 offset:36864
v_cvt_pk_bf16_f32 v145, v170, v171
v_mfma_f32_16x16x32_bf16 v[8:11], a[32:35], v[152:155], 0
v_exp_f32 v172, v124 clamp
v_mfma_f32_16x16x32_bf16 v[20:23], a[36:39], v[152:155], 0
v_exp_f32 v173, v125 clamp
v_mfma_f32_16x16x32_bf16 v[32:35], a[40:43], v[152:155], 0
s_add_u32 m0, s43, 0
ds_read_b128 a[24:27], v218 offset:36864
v_cvt_pk_bf16_f32 v146, v172, v173
v_mfma_f32_16x16x32_bf16 v[44:47], a[44:47], v[152:155], 0
buffer_load_dwordx4 v244, s[16:19], s46 offen offset:0 nt lds
v_mfma_f32_16x16x32_bf16 v[56:59], a[48:51], v[152:155], 0
ds_read_b128 a[28:31], v219 offset:36864
v_mfma_f32_16x16x32_bf16 v[68:71], a[52:55], v[152:155], 0
v_exp_f32 v174, v126 clamp
v_mfma_f32_16x16x32_bf16 v[80:83], a[56:59], v[152:155], 0
v_exp_f32 v175, v127 clamp
v_mfma_f32_16x16x32_bf16 v[92:95], a[60:63], v[152:155], 0
s_waitcnt lgkmcnt(1)
v_cvt_pk_bf16_f32 v147, v174, v175
v_mfma_f32_16x16x32_bf16 v[96:99], a[0:3], a[80:83], v[156:159]
s_waitcnt vmcnt(1)
s_barrier
v_exp_f32 v168, v128 clamp
v_mfma_f32_16x16x32_bf16 v[96:99], a[4:7], a[84:87], v[96:99]
buffer_load_dwordx4 v245, s[16:19], s46 offen offset:1024 nt lds
ds_read_b64_tr_b16 a[32:33], v220 offset:16384
ds_read_b64_tr_b16 a[34:35], v220 offset:20480
v_mfma_f32_16x16x32_bf16 v[96:99], a[8:11], a[88:91], v[96:99]
v_exp_f32 v169, v129 clamp
v_mfma_f32_16x16x32_bf16 v[176:179], a[64:67], v[144:147], v[176:179]
ds_read_b64_tr_b16 a[36:37], v221 offset:16384
v_cvt_pk_bf16_f32 v148, v168, v169
v_mfma_f32_16x16x32_bf16 v[96:99], a[12:15], a[92:95], v[96:99]
v_mfma_f32_16x16x32_bf16 v[100:103], a[16:19], a[80:83], v[156:159]
buffer_load_dwordx4 v244, s[16:19], s46 offen offset:2048 nt lds
v_exp_f32 v170, v130 clamp
v_mfma_f32_16x16x32_bf16 v[100:103], a[20:23], a[84:87], v[100:103]
s_waitcnt lgkmcnt(3)
ds_read_b64_tr_b16 a[38:39], v221 offset:20480
ds_read_b64_tr_b16 a[40:41], v222 offset:16384
v_mfma_f32_16x16x32_bf16 v[100:103], a[24:27], a[88:91], v[100:103]
v_exp_f32 v171, v131 clamp
v_mfma_f32_16x16x32_bf16 v[100:103], a[28:31], a[92:95], v[100:103]
ds_read_b64_tr_b16 a[42:43], v222 offset:20480
v_cvt_pk_bf16_f32 v149, v170, v171
v_mfma_f32_16x16x32_bf16 v[104:107], a[0:3], a[96:99], v[160:163]
buffer_load_dwordx4 v245, s[16:19], s46 offen offset:3072 nt lds
s_add_u32 s46, s46, 16384
v_exp_f32 v172, v132 clamp
v_mfma_f32_16x16x32_bf16 v[104:107], a[4:7], a[100:103], v[104:107]
v_mfma_f32_16x16x32_bf16 v[104:107], a[8:11], a[104:107], v[104:107]
ds_read_b64_tr_b16 a[44:45], v223 offset:16384
ds_read_b64_tr_b16 a[46:47], v223 offset:20480
v_mfma_f32_16x16x32_bf16 v[104:107], a[12:15], a[108:111], v[104:107]
s_add_u32 m0, s43, 98304
v_exp_f32 v173, v133 clamp
v_mfma_f32_16x16x32_bf16 v[108:111], a[16:19], a[96:99], v[160:163]
buffer_load_dwordx4 v244, s[20:23], s47 offen offset:0 nt lds
ds_read_b64_tr_b16 a[48:49], v224 offset:16384
v_cvt_pk_bf16_f32 v150, v172, v173
v_mfma_f32_16x16x32_bf16 v[108:111], a[20:23], a[100:103], v[108:111]
v_exp_f32 v174, v134 clamp
v_mfma_f32_16x16x32_bf16 v[108:111], a[24:27], a[104:107], v[108:111]
ds_read_b64_tr_b16 a[50:51], v224 offset:20480
ds_read_b64_tr_b16 a[52:53], v225 offset:16384
v_mfma_f32_16x16x32_bf16 v[108:111], a[28:31], a[108:111], v[108:111]
v_cmp_ngt_f32 vcc, 1.0, v176
v_mfma_f32_16x16x32_bf16 v[112:115], a[0:3], a[112:115], v[164:167]
buffer_load_dwordx4 v245, s[20:23], s47 offen offset:1024 nt lds
v_exp_f32 v175, v135 clamp
v_mfma_f32_16x16x32_bf16 v[112:115], a[4:7], a[116:119], v[112:115]
s_cbranch_vccnz L_rs_sa1_0
L_rs_sa1_0_ret:
ds_read_b64_tr_b16 a[54:55], v225 offset:20480
ds_read_b64_tr_b16 a[56:57], v226 offset:16384
v_mfma_f32_16x16x32_bf16 v[112:115], a[8:11], a[120:123], v[112:115]
ds_read_b64_tr_b16 a[58:59], v226 offset:20480
v_cvt_pk_bf16_f32 v151, v174, v175
v_mfma_f32_16x16x32_bf16 v[112:115], a[12:15], a[124:127], v[112:115]
ds_read_b64_tr_b16 a[60:61], v227 offset:16384
ds_read_b64_tr_b16 a[62:63], v227 offset:20480
v_mfma_f32_16x16x32_bf16 v[116:119], a[16:19], a[112:115], v[164:167]
buffer_load_dwordx4 v244, s[20:23], s47 offen offset:2048 nt lds
v_exp_f32 v168, v136 clamp
v_mfma_f32_16x16x32_bf16 v[116:119], a[20:23], a[116:119], v[116:119]
v_mfma_f32_16x16x32_bf16 v[180:183], a[64:67], v[148:151], v[180:183]
v_exp_f32 v169, v137 clamp
v_mfma_f32_16x16x32_bf16 v[116:119], a[24:27], a[120:123], v[116:119]
s_waitcnt lgkmcnt(0)
v_exp_f32 v170, v138 clamp
v_mfma_f32_16x16x32_bf16 v[116:119], a[28:31], a[124:127], v[116:119]
buffer_load_dwordx4 v245, s[20:23], s47 offen offset:3072 nt lds
s_add_u32 s47, s47, 16384
v_exp_f32 v171, v139 clamp
v_mfma_f32_16x16x32_bf16 v[0:3], a[32:35], v[144:147], v[0:3]
ds_read_b128 a[0:3], v216 offset:49152
v_cvt_pk_bf16_f32 v152, v168, v169
v_mfma_f32_16x16x32_bf16 v[12:15], a[36:39], v[144:147], v[12:15]
v_exp_f32 v172, v140 clamp
v_mfma_f32_16x16x32_bf16 v[24:27], a[40:43], v[144:147], v[24:27]
v_cmp_ngt_f32 vcc, 1.0, v180
v_mfma_f32_16x16x32_bf16 v[36:39], a[44:47], v[144:147], v[36:39]
ds_read_b128 a[4:7], v217 offset:49152
v_cvt_pk_bf16_f32 v153, v170, v171
v_mfma_f32_16x16x32_bf16 v[48:51], a[48:51], v[144:147], v[48:51]
s_cbranch_vccnz L_rs_sa1_1
L_rs_sa1_1_ret:
v_exp_f32 v173, v141 clamp
v_mfma_f32_16x16x32_bf16 v[60:63], a[52:55], v[144:147], v[60:63]
v_exp_f32 v174, v142 clamp
v_mfma_f32_16x16x32_bf16 v[72:75], a[56:59], v[144:147], v[72:75]
ds_read_b128 a[8:11], v218 offset:49152
v_cvt_pk_bf16_f32 v154, v172, v173
v_mfma_f32_16x16x32_bf16 v[84:87], a[60:63], v[144:147], v[84:87]
v_exp_f32 v175, v143 clamp
v_mfma_f32_16x16x32_bf16 v[4:7], a[32:35], v[148:151], v[4:7]
v_mfma_f32_16x16x32_bf16 v[16:19], a[36:39], v[148:151], v[16:19]
s_add_u32 m0, s43, 16384
ds_read_b128 a[12:15], v219 offset:49152
v_cvt_pk_bf16_f32 v155, v174, v175
v_mfma_f32_16x16x32_bf16 v[28:31], a[40:43], v[148:151], v[28:31]
buffer_load_dwordx4 v244, s[16:19], s46 offen offset:0 nt lds
v_exp_f32 v168, v96 clamp
v_mfma_f32_16x16x32_bf16 v[184:187], a[64:67], v[152:155], v[184:187]
v_exp_f32 v169, v97 clamp
v_mfma_f32_16x16x32_bf16 v[40:43], a[44:47], v[148:151], v[40:43]
ds_read_b128 a[16:19], v216 offset:53248
v_cvt_pk_bf16_f32 v144, v168, v169
v_mfma_f32_16x16x32_bf16 v[52:55], a[48:51], v[148:151], v[52:55]
v_exp_f32 v170, v98 clamp
v_mfma_f32_16x16x32_bf16 v[64:67], a[52:55], v[148:151], v[64:67]
buffer_load_dwordx4 v245, s[16:19], s46 offen offset:1024 nt lds
v_mfma_f32_16x16x32_bf16 v[76:79], a[56:59], v[148:151], v[76:79]
v_exp_f32 v171, v99 clamp
v_cmp_ngt_f32 vcc, 1.0, v184
v_mfma_f32_16x16x32_bf16 v[88:91], a[60:63], v[148:151], v[88:91]
s_cbranch_vccnz L_rs_sa1_2
L_rs_sa1_2_ret:
ds_read_b128 a[20:23], v217 offset:53248
v_cvt_pk_bf16_f32 v145, v170, v171
v_mfma_f32_16x16x32_bf16 v[8:11], a[32:35], v[152:155], v[8:11]
v_exp_f32 v172, v100 clamp
v_mfma_f32_16x16x32_bf16 v[20:23], a[36:39], v[152:155], v[20:23]
buffer_load_dwordx4 v244, s[16:19], s46 offen offset:2048 nt lds
v_exp_f32 v173, v101 clamp
v_mfma_f32_16x16x32_bf16 v[32:35], a[40:43], v[152:155], v[32:35]
ds_read_b128 a[24:27], v218 offset:53248
v_cvt_pk_bf16_f32 v146, v172, v173
v_mfma_f32_16x16x32_bf16 v[44:47], a[44:47], v[152:155], v[44:47]
v_mfma_f32_16x16x32_bf16 v[56:59], a[48:51], v[152:155], v[56:59]
ds_read_b128 a[28:31], v219 offset:53248
v_mfma_f32_16x16x32_bf16 v[68:71], a[52:55], v[152:155], v[68:71]
buffer_load_dwordx4 v245, s[16:19], s46 offen offset:3072 nt lds
s_add_u32 s46, s46, 16384
v_exp_f32 v174, v102 clamp
v_mfma_f32_16x16x32_bf16 v[80:83], a[56:59], v[152:155], v[80:83]
v_exp_f32 v175, v103 clamp
v_mfma_f32_16x16x32_bf16 v[92:95], a[60:63], v[152:155], v[92:95]
s_waitcnt lgkmcnt(1)
v_cvt_pk_bf16_f32 v147, v174, v175
v_mfma_f32_16x16x32_bf16 v[120:123], a[0:3], a[80:83], v[156:159]
s_waitcnt vmcnt(4)
s_barrier
s_add_u32 m0, s43, 114688
v_exp_f32 v168, v104 clamp
v_mfma_f32_16x16x32_bf16 v[120:123], a[4:7], a[84:87], v[120:123]
buffer_load_dwordx4 v244, s[20:23], s47 offen offset:0 nt lds
ds_read_b64_tr_b16 a[32:33], v220 offset:32768
ds_read_b64_tr_b16 a[34:35], v220 offset:36864
v_mfma_f32_16x16x32_bf16 v[120:123], a[8:11], a[88:91], v[120:123]
v_exp_f32 v169, v105 clamp
v_mfma_f32_16x16x32_bf16 v[176:179], a[64:67], v[144:147], v[176:179]
ds_read_b64_tr_b16 a[36:37], v221 offset:32768
v_cvt_pk_bf16_f32 v148, v168, v169
v_mfma_f32_16x16x32_bf16 v[120:123], a[12:15], a[92:95], v[120:123]
v_mfma_f32_16x16x32_bf16 v[124:127], a[16:19], a[80:83], v[156:159]
buffer_load_dwordx4 v245, s[20:23], s47 offen offset:1024 nt lds
v_exp_f32 v170, v106 clamp
v_mfma_f32_16x16x32_bf16 v[124:127], a[20:23], a[84:87], v[124:127]
s_waitcnt lgkmcnt(3)
ds_read_b64_tr_b16 a[38:39], v221 offset:36864
ds_read_b64_tr_b16 a[40:41], v222 offset:32768
v_mfma_f32_16x16x32_bf16 v[124:127], a[24:27], a[88:91], v[124:127]
v_exp_f32 v171, v107 clamp
v_mfma_f32_16x16x32_bf16 v[124:127], a[28:31], a[92:95], v[124:127]
ds_read_b64_tr_b16 a[42:43], v222 offset:36864
v_cvt_pk_bf16_f32 v149, v170, v171
v_mfma_f32_16x16x32_bf16 v[128:131], a[0:3], a[96:99], v[160:163]
buffer_load_dwordx4 v244, s[20:23], s47 offen offset:2048 nt lds
v_exp_f32 v172, v108 clamp
v_mfma_f32_16x16x32_bf16 v[128:131], a[4:7], a[100:103], v[128:131]
v_mfma_f32_16x16x32_bf16 v[128:131], a[8:11], a[104:107], v[128:131]
ds_read_b64_tr_b16 a[44:45], v223 offset:32768
ds_read_b64_tr_b16 a[46:47], v223 offset:36864
v_mfma_f32_16x16x32_bf16 v[128:131], a[12:15], a[108:111], v[128:131]
v_exp_f32 v173, v109 clamp
v_mfma_f32_16x16x32_bf16 v[132:135], a[16:19], a[96:99], v[160:163]
buffer_load_dwordx4 v245, s[20:23], s47 offen offset:3072 nt lds
s_add_u32 s47, s47, 16384
ds_read_b64_tr_b16 a[48:49], v224 offset:32768
v_cvt_pk_bf16_f32 v150, v172, v173
v_mfma_f32_16x16x32_bf16 v[132:135], a[20:23], a[100:103], v[132:135]
v_exp_f32 v174, v110 clamp
v_mfma_f32_16x16x32_bf16 v[132:135], a[24:27], a[104:107], v[132:135]
ds_read_b64_tr_b16 a[50:51], v224 offset:36864
ds_read_b64_tr_b16 a[52:53], v225 offset:32768
v_mfma_f32_16x16x32_bf16 v[132:135], a[28:31], a[108:111], v[132:135]
v_cmp_ngt_f32 vcc, 1.0, v176
v_mfma_f32_16x16x32_bf16 v[136:139], a[0:3], a[112:115], v[164:167]
v_exp_f32 v175, v111 clamp
v_mfma_f32_16x16x32_bf16 v[136:139], a[4:7], a[116:119], v[136:139]
s_cbranch_vccnz L_rs_sa2_0
L_rs_sa2_0_ret:
ds_read_b64_tr_b16 a[54:55], v225 offset:36864
ds_read_b64_tr_b16 a[56:57], v226 offset:32768
v_mfma_f32_16x16x32_bf16 v[136:139], a[8:11], a[120:123], v[136:139]
ds_read_b64_tr_b16 a[58:59], v226 offset:36864
v_cvt_pk_bf16_f32 v151, v174, v175
v_mfma_f32_16x16x32_bf16 v[136:139], a[12:15], a[124:127], v[136:139]
ds_read_b64_tr_b16 a[60:61], v227 offset:32768
ds_read_b64_tr_b16 a[62:63], v227 offset:36864
v_mfma_f32_16x16x32_bf16 v[140:143], a[16:19], a[112:115], v[164:167]
s_add_u32 m0, s43, 32768
v_exp_f32 v168, v112 clamp
v_mfma_f32_16x16x32_bf16 v[140:143], a[20:23], a[116:119], v[140:143]
buffer_load_dwordx4 v244, s[16:19], s46 offen offset:0 nt lds
v_mfma_f32_16x16x32_bf16 v[180:183], a[64:67], v[148:151], v[180:183]
v_exp_f32 v169, v113 clamp
v_mfma_f32_16x16x32_bf16 v[140:143], a[24:27], a[120:123], v[140:143]
s_waitcnt lgkmcnt(0)
v_exp_f32 v170, v114 clamp
v_mfma_f32_16x16x32_bf16 v[140:143], a[28:31], a[124:127], v[140:143]
v_exp_f32 v171, v115 clamp
v_mfma_f32_16x16x32_bf16 v[0:3], a[32:35], v[144:147], v[0:3]
ds_read_b128 a[0:3], v216 offset:0
v_cvt_pk_bf16_f32 v152, v168, v169
v_mfma_f32_16x16x32_bf16 v[12:15], a[36:39], v[144:147], v[12:15]
buffer_load_dwordx4 v245, s[16:19], s46 offen offset:1024 nt lds
v_exp_f32 v172, v116 clamp
v_mfma_f32_16x16x32_bf16 v[24:27], a[40:43], v[144:147], v[24:27]
v_cmp_ngt_f32 vcc, 1.0, v180
v_mfma_f32_16x16x32_bf16 v[36:39], a[44:47], v[144:147], v[36:39]
ds_read_b128 a[4:7], v217 offset:0
v_cvt_pk_bf16_f32 v153, v170, v171
v_mfma_f32_16x16x32_bf16 v[48:51], a[48:51], v[144:147], v[48:51]
s_cbranch_vccnz L_rs_sa2_1
L_rs_sa2_1_ret:
v_exp_f32 v173, v117 clamp
v_mfma_f32_16x16x32_bf16 v[60:63], a[52:55], v[144:147], v[60:63]
v_exp_f32 v174, v118 clamp
v_mfma_f32_16x16x32_bf16 v[72:75], a[56:59], v[144:147], v[72:75]
buffer_load_dwordx4 v244, s[16:19], s46 offen offset:2048 nt lds
ds_read_b128 a[8:11], v218 offset:0
v_cvt_pk_bf16_f32 v154, v172, v173
v_mfma_f32_16x16x32_bf16 v[84:87], a[60:63], v[144:147], v[84:87]
v_exp_f32 v175, v119 clamp
v_mfma_f32_16x16x32_bf16 v[4:7], a[32:35], v[148:151], v[4:7]
v_mfma_f32_16x16x32_bf16 v[16:19], a[36:39], v[148:151], v[16:19]
ds_read_b128 a[12:15], v219 offset:0
v_cvt_pk_bf16_f32 v155, v174, v175
v_mfma_f32_16x16x32_bf16 v[28:31], a[40:43], v[148:151], v[28:31]
v_exp_f32 v168, v120 clamp
v_mfma_f32_16x16x32_bf16 v[184:187], a[64:67], v[152:155], v[184:187]
buffer_load_dwordx4 v245, s[16:19], s46 offen offset:3072 nt lds
s_add_u32 s46, s46, 16384
v_exp_f32 v169, v121 clamp
v_mfma_f32_16x16x32_bf16 v[40:43], a[44:47], v[148:151], v[40:43]
ds_read_b128 a[16:19], v216 offset:4096
v_cvt_pk_bf16_f32 v144, v168, v169
v_mfma_f32_16x16x32_bf16 v[52:55], a[48:51], v[148:151], v[52:55]
v_exp_f32 v170, v122 clamp
v_mfma_f32_16x16x32_bf16 v[64:67], a[52:55], v[148:151], v[64:67]
v_mfma_f32_16x16x32_bf16 v[76:79], a[56:59], v[148:151], v[76:79]
s_add_u32 m0, s43, 65536
v_exp_f32 v171, v123 clamp
v_cmp_ngt_f32 vcc, 1.0, v184
v_mfma_f32_16x16x32_bf16 v[88:91], a[60:63], v[148:151], v[88:91]
buffer_load_dwordx4 v244, s[20:23], s47 offen offset:0 nt lds
s_cbranch_vccnz L_rs_sa2_2
L_rs_sa2_2_ret:
ds_read_b128 a[20:23], v217 offset:4096
v_cvt_pk_bf16_f32 v145, v170, v171
v_mfma_f32_16x16x32_bf16 v[8:11], a[32:35], v[152:155], v[8:11]
v_exp_f32 v172, v124 clamp
v_mfma_f32_16x16x32_bf16 v[20:23], a[36:39], v[152:155], v[20:23]
v_exp_f32 v173, v125 clamp
v_mfma_f32_16x16x32_bf16 v[32:35], a[40:43], v[152:155], v[32:35]
ds_read_b128 a[24:27], v218 offset:4096
v_cvt_pk_bf16_f32 v146, v172, v173
v_mfma_f32_16x16x32_bf16 v[44:47], a[44:47], v[152:155], v[44:47]
v_mfma_f32_16x16x32_bf16 v[56:59], a[48:51], v[152:155], v[56:59]
buffer_load_dwordx4 v245, s[20:23], s47 offen offset:1024 nt lds
ds_read_b128 a[28:31], v219 offset:4096
v_mfma_f32_16x16x32_bf16 v[68:71], a[52:55], v[152:155], v[68:71]
v_exp_f32 v174, v126 clamp
v_mfma_f32_16x16x32_bf16 v[80:83], a[56:59], v[152:155], v[80:83]
v_exp_f32 v175, v127 clamp
v_mfma_f32_16x16x32_bf16 v[92:95], a[60:63], v[152:155], v[92:95]
s_waitcnt lgkmcnt(1)
v_cvt_pk_bf16_f32 v147, v174, v175
v_mfma_f32_16x16x32_bf16 v[96:99], a[0:3], a[80:83], v[156:159]
s_waitcnt vmcnt(6)
s_barrier
v_exp_f32 v168, v128 clamp
v_mfma_f32_16x16x32_bf16 v[96:99], a[4:7], a[84:87], v[96:99]
buffer_load_dwordx4 v244, s[20:23], s47 offen offset:2048 nt lds
ds_read_b64_tr_b16 a[32:33], v220 offset:49152
ds_read_b64_tr_b16 a[34:35], v220 offset:53248
v_mfma_f32_16x16x32_bf16 v[96:99], a[8:11], a[88:91], v[96:99]
v_exp_f32 v169, v129 clamp
v_mfma_f32_16x16x32_bf16 v[176:179], a[64:67], v[144:147], v[176:179]
ds_read_b64_tr_b16 a[36:37], v221 offset:49152
v_cvt_pk_bf16_f32 v148, v168, v169
v_mfma_f32_16x16x32_bf16 v[96:99], a[12:15], a[92:95], v[96:99]
v_mfma_f32_16x16x32_bf16 v[100:103], a[16:19], a[80:83], v[156:159]
v_exp_f32 v170, v130 clamp
v_mfma_f32_16x16x32_bf16 v[100:103], a[20:23], a[84:87], v[100:103]
buffer_load_dwordx4 v245, s[20:23], s47 offen offset:3072 nt lds
s_waitcnt lgkmcnt(3)
s_add_u32 s47, s47, 16384
ds_read_b64_tr_b16 a[38:39], v221 offset:53248
ds_read_b64_tr_b16 a[40:41], v222 offset:49152
v_mfma_f32_16x16x32_bf16 v[100:103], a[24:27], a[88:91], v[100:103]
s_add_u32 m0, s43, 49152
v_exp_f32 v171, v131 clamp
v_mfma_f32_16x16x32_bf16 v[100:103], a[28:31], a[92:95], v[100:103]
buffer_load_dwordx4 v244, s[16:19], s46 offen offset:0 nt lds
ds_read_b64_tr_b16 a[42:43], v222 offset:53248
v_cvt_pk_bf16_f32 v149, v170, v171
v_mfma_f32_16x16x32_bf16 v[104:107], a[0:3], a[96:99], v[160:163]
v_exp_f32 v172, v132 clamp
v_mfma_f32_16x16x32_bf16 v[104:107], a[4:7], a[100:103], v[104:107]
buffer_load_dwordx4 v245, s[16:19], s46 offen offset:1024 nt lds
v_mfma_f32_16x16x32_bf16 v[104:107], a[8:11], a[104:107], v[104:107]
ds_read_b64_tr_b16 a[44:45], v223 offset:49152
ds_read_b64_tr_b16 a[46:47], v223 offset:53248
v_mfma_f32_16x16x32_bf16 v[104:107], a[12:15], a[108:111], v[104:107]
v_exp_f32 v173, v133 clamp
v_mfma_f32_16x16x32_bf16 v[108:111], a[16:19], a[96:99], v[160:163]
ds_read_b64_tr_b16 a[48:49], v224 offset:49152
v_cvt_pk_bf16_f32 v150, v172, v173
v_mfma_f32_16x16x32_bf16 v[108:111], a[20:23], a[100:103], v[108:111]
v_exp_f32 v174, v134 clamp
v_mfma_f32_16x16x32_bf16 v[108:111], a[24:27], a[104:107], v[108:111]
ds_read_b64_tr_b16 a[50:51], v224 offset:53248
ds_read_b64_tr_b16 a[52:53], v225 offset:49152
v_mfma_f32_16x16x32_bf16 v[108:111], a[28:31], a[108:111], v[108:111]
buffer_load_dwordx4 v244, s[16:19], s46 offen offset:2048 nt lds
v_cmp_ngt_f32 vcc, 1.0, v176
v_mfma_f32_16x16x32_bf16 v[112:115], a[0:3], a[112:115], v[164:167]
v_exp_f32 v175, v135 clamp
v_mfma_f32_16x16x32_bf16 v[112:115], a[4:7], a[116:119], v[112:115]
s_cbranch_vccnz L_rs_sa3_0
L_rs_sa3_0_ret:
ds_read_b64_tr_b16 a[54:55], v225 offset:53248
ds_read_b64_tr_b16 a[56:57], v226 offset:49152
v_mfma_f32_16x16x32_bf16 v[112:115], a[8:11], a[120:123], v[112:115]
ds_read_b64_tr_b16 a[58:59], v226 offset:53248
v_cvt_pk_bf16_f32 v151, v174, v175
v_mfma_f32_16x16x32_bf16 v[112:115], a[12:15], a[124:127], v[112:115]
ds_read_b64_tr_b16 a[60:61], v227 offset:49152
ds_read_b64_tr_b16 a[62:63], v227 offset:53248
v_mfma_f32_16x16x32_bf16 v[116:119], a[16:19], a[112:115], v[164:167]
v_exp_f32 v168, v136 clamp
v_mfma_f32_16x16x32_bf16 v[116:119], a[20:23], a[116:119], v[116:119]
buffer_load_dwordx4 v245, s[16:19], s46 offen offset:3072 nt lds
s_add_u32 s46, s46, 16384
v_mfma_f32_16x16x32_bf16 v[180:183], a[64:67], v[148:151], v[180:183]
v_exp_f32 v169, v137 clamp
v_mfma_f32_16x16x32_bf16 v[116:119], a[24:27], a[120:123], v[116:119]
s_waitcnt lgkmcnt(0)
v_exp_f32 v170, v138 clamp
v_mfma_f32_16x16x32_bf16 v[116:119], a[28:31], a[124:127], v[116:119]
v_exp_f32 v171, v139 clamp
v_mfma_f32_16x16x32_bf16 v[0:3], a[32:35], v[144:147], v[0:3]
ds_read_b128 a[0:3], v216 offset:16384
v_cvt_pk_bf16_f32 v152, v168, v169
v_mfma_f32_16x16x32_bf16 v[12:15], a[36:39], v[144:147], v[12:15]
s_add_u32 m0, s43, 81920
v_exp_f32 v172, v140 clamp
v_mfma_f32_16x16x32_bf16 v[24:27], a[40:43], v[144:147], v[24:27]
buffer_load_dwordx4 v244, s[20:23], s47 offen offset:0 nt lds
v_cmp_ngt_f32 vcc, 1.0, v180
v_mfma_f32_16x16x32_bf16 v[36:39], a[44:47], v[144:147], v[36:39]
ds_read_b128 a[4:7], v217 offset:16384
v_cvt_pk_bf16_f32 v153, v170, v171
v_mfma_f32_16x16x32_bf16 v[48:51], a[48:51], v[144:147], v[48:51]
s_cbranch_vccnz L_rs_sa3_1
L_rs_sa3_1_ret:
v_exp_f32 v173, v141 clamp
v_mfma_f32_16x16x32_bf16 v[60:63], a[52:55], v[144:147], v[60:63]
v_exp_f32 v174, v142 clamp
v_mfma_f32_16x16x32_bf16 v[72:75], a[56:59], v[144:147], v[72:75]
ds_read_b128 a[8:11], v218 offset:16384
v_cvt_pk_bf16_f32 v154, v172, v173
v_mfma_f32_16x16x32_bf16 v[84:87], a[60:63], v[144:147], v[84:87]
v_exp_f32 v175, v143 clamp
v_mfma_f32_16x16x32_bf16 v[4:7], a[32:35], v[148:151], v[4:7]
buffer_load_dwordx4 v245, s[20:23], s47 offen offset:1024 nt lds
v_mfma_f32_16x16x32_bf16 v[16:19], a[36:39], v[148:151], v[16:19]
ds_read_b128 a[12:15], v219 offset:16384
v_cvt_pk_bf16_f32 v155, v174, v175
v_mfma_f32_16x16x32_bf16 v[28:31], a[40:43], v[148:151], v[28:31]
v_exp_f32 v168, v96 clamp
v_mfma_f32_16x16x32_bf16 v[184:187], a[64:67], v[152:155], v[184:187]
v_exp_f32 v169, v97 clamp
v_mfma_f32_16x16x32_bf16 v[40:43], a[44:47], v[148:151], v[40:43]
ds_read_b128 a[16:19], v216 offset:20480
v_cvt_pk_bf16_f32 v144, v168, v169
v_mfma_f32_16x16x32_bf16 v[52:55], a[48:51], v[148:151], v[52:55]
v_exp_f32 v170, v98 clamp
v_mfma_f32_16x16x32_bf16 v[64:67], a[52:55], v[148:151], v[64:67]
buffer_load_dwordx4 v244, s[20:23], s47 offen offset:2048 nt lds
v_mfma_f32_16x16x32_bf16 v[76:79], a[56:59], v[148:151], v[76:79]
v_exp_f32 v171, v99 clamp
v_cmp_ngt_f32 vcc, 1.0, v184
v_mfma_f32_16x16x32_bf16 v[88:91], a[60:63], v[148:151], v[88:91]
s_cbranch_vccnz L_rs_sa3_2
L_rs_sa3_2_ret:
ds_read_b128 a[20:23], v217 offset:20480
v_cvt_pk_bf16_f32 v145, v170, v171
v_mfma_f32_16x16x32_bf16 v[8:11], a[32:35], v[152:155], v[8:11]
v_exp_f32 v172, v100 clamp
v_mfma_f32_16x16x32_bf16 v[20:23], a[36:39], v[152:155], v[20:23]
v_exp_f32 v173, v101 clamp
v_mfma_f32_16x16x32_bf16 v[32:35], a[40:43], v[152:155], v[32:35]
ds_read_b128 a[24:27], v218 offset:20480
v_cvt_pk_bf16_f32 v146, v172, v173
v_mfma_f32_16x16x32_bf16 v[44:47], a[44:47], v[152:155], v[44:47]
buffer_load_dwordx4 v245, s[20:23], s47 offen offset:3072 nt lds
s_add_u32 s47, s47, 16384
v_mfma_f32_16x16x32_bf16 v[56:59], a[48:51], v[152:155], v[56:59]
ds_read_b128 a[28:31], v219 offset:20480
v_mfma_f32_16x16x32_bf16 v[68:71], a[52:55], v[152:155], v[68:71]
v_exp_f32 v174, v102 clamp
v_mfma_f32_16x16x32_bf16 v[80:83], a[56:59], v[152:155], v[80:83]
v_exp_f32 v175, v103 clamp
v_mfma_f32_16x16x32_bf16 v[92:95], a[60:63], v[152:155], v[92:95]
s_waitcnt lgkmcnt(1)
v_cvt_pk_bf16_f32 v147, v174, v175
v_mfma_f32_16x16x32_bf16 v[120:123], a[0:3], a[80:83], v[156:159]
s_waitcnt vmcnt(8)
s_barrier
v_exp_f32 v168, v104 clamp
v_mfma_f32_16x16x32_bf16 v[120:123], a[4:7], a[84:87], v[120:123]
ds_read_b64_tr_b16 a[32:33], v220 offset:0
ds_read_b64_tr_b16 a[34:35], v220 offset:4096
v_mfma_f32_16x16x32_bf16 v[120:123], a[8:11], a[88:91], v[120:123]
v_exp_f32 v169, v105 clamp
v_mfma_f32_16x16x32_bf16 v[176:179], a[64:67], v[144:147], v[176:179]
s_add_u32 m0, s43, 0
ds_read_b64_tr_b16 a[36:37], v221 offset:0
v_cvt_pk_bf16_f32 v148, v168, v169
v_mfma_f32_16x16x32_bf16 v[120:123], a[12:15], a[92:95], v[120:123]
buffer_load_dwordx4 v244, s[16:19], s46 offen offset:0 nt lds
v_mfma_f32_16x16x32_bf16 v[124:127], a[16:19], a[80:83], v[156:159]
v_exp_f32 v170, v106 clamp
v_mfma_f32_16x16x32_bf16 v[124:127], a[20:23], a[84:87], v[124:127]
s_waitcnt lgkmcnt(3)
ds_read_b64_tr_b16 a[38:39], v221 offset:4096
ds_read_b64_tr_b16 a[40:41], v222 offset:0
v_mfma_f32_16x16x32_bf16 v[124:127], a[24:27], a[88:91], v[124:127]
v_exp_f32 v171, v107 clamp
v_mfma_f32_16x16x32_bf16 v[124:127], a[28:31], a[92:95], v[124:127]
ds_read_b64_tr_b16 a[42:43], v222 offset:4096
v_cvt_pk_bf16_f32 v149, v170, v171
v_mfma_f32_16x16x32_bf16 v[128:131], a[0:3], a[96:99], v[160:163]
v_exp_f32 v172, v108 clamp
v_mfma_f32_16x16x32_bf16 v[128:131], a[4:7], a[100:103], v[128:131]
buffer_load_dwordx4 v245, s[16:19], s46 offen offset:1024 nt lds
v_mfma_f32_16x16x32_bf16 v[128:131], a[8:11], a[104:107], v[128:131]
ds_read_b64_tr_b16 a[44:45], v223 offset:0
ds_read_b64_tr_b16 a[46:47], v223 offset:4096
v_mfma_f32_16x16x32_bf16 v[128:131], a[12:15], a[108:111], v[128:131]
v_exp_f32 v173, v109 clamp
v_mfma_f32_16x16x32_bf16 v[132:135], a[16:19], a[96:99], v[160:163]
ds_read_b64_tr_b16 a[48:49], v224 offset:0
v_cvt_pk_bf16_f32 v150, v172, v173
v_mfma_f32_16x16x32_bf16 v[132:135], a[20:23], a[100:103], v[132:135]
v_exp_f32 v174, v110 clamp
v_mfma_f32_16x16x32_bf16 v[132:135], a[24:27], a[104:107], v[132:135]
ds_read_b64_tr_b16 a[50:51], v224 offset:4096
ds_read_b64_tr_b16 a[52:53], v225 offset:0
v_mfma_f32_16x16x32_bf16 v[132:135], a[28:31], a[108:111], v[132:135]
buffer_load_dwordx4 v244, s[16:19], s46 offen offset:2048 nt lds
v_cmp_ngt_f32 vcc, 1.0, v176
v_mfma_f32_16x16x32_bf16 v[136:139], a[0:3], a[112:115], v[164:167]
v_exp_f32 v175, v111 clamp
v_mfma_f32_16x16x32_bf16 v[136:139], a[4:7], a[116:119], v[136:139]
s_cbranch_vccnz L_rs_sa4_0
L_rs_sa4_0_ret:
ds_read_b64_tr_b16 a[54:55], v225 offset:4096
ds_read_b64_tr_b16 a[56:57], v226 offset:0
v_mfma_f32_16x16x32_bf16 v[136:139], a[8:11], a[120:123], v[136:139]
ds_read_b64_tr_b16 a[58:59], v226 offset:4096
v_cvt_pk_bf16_f32 v151, v174, v175
v_mfma_f32_16x16x32_bf16 v[136:139], a[12:15], a[124:127], v[136:139]
ds_read_b64_tr_b16 a[60:61], v227 offset:0
ds_read_b64_tr_b16 a[62:63], v227 offset:4096
v_mfma_f32_16x16x32_bf16 v[140:143], a[16:19], a[112:115], v[164:167]
v_exp_f32 v168, v112 clamp
v_mfma_f32_16x16x32_bf16 v[140:143], a[20:23], a[116:119], v[140:143]
buffer_load_dwordx4 v245, s[16:19], s46 offen offset:3072 nt lds
s_add_u32 s46, s46, 16384
v_mfma_f32_16x16x32_bf16 v[180:183], a[64:67], v[148:151], v[180:183]
v_exp_f32 v169, v113 clamp
v_mfma_f32_16x16x32_bf16 v[140:143], a[24:27], a[120:123], v[140:143]
s_waitcnt lgkmcnt(0)
v_exp_f32 v170, v114 clamp
v_mfma_f32_16x16x32_bf16 v[140:143], a[28:31], a[124:127], v[140:143]
v_exp_f32 v171, v115 clamp
v_mfma_f32_16x16x32_bf16 v[0:3], a[32:35], v[144:147], v[0:3]
ds_read_b128 a[0:3], v216 offset:32768
v_cvt_pk_bf16_f32 v152, v168, v169
v_mfma_f32_16x16x32_bf16 v[12:15], a[36:39], v[144:147], v[12:15]
s_add_u32 m0, s43, 98304
v_exp_f32 v172, v116 clamp
v_mfma_f32_16x16x32_bf16 v[24:27], a[40:43], v[144:147], v[24:27]
buffer_load_dwordx4 v244, s[20:23], s47 offen offset:0 nt lds
v_cmp_ngt_f32 vcc, 1.0, v180
v_mfma_f32_16x16x32_bf16 v[36:39], a[44:47], v[144:147], v[36:39]
ds_read_b128 a[4:7], v217 offset:32768
v_cvt_pk_bf16_f32 v153, v170, v171
v_mfma_f32_16x16x32_bf16 v[48:51], a[48:51], v[144:147], v[48:51]
s_cbranch_vccnz L_rs_sa4_1
L_rs_sa4_1_ret:
v_exp_f32 v173, v117 clamp
v_mfma_f32_16x16x32_bf16 v[60:63], a[52:55], v[144:147], v[60:63]
v_exp_f32 v174, v118 clamp
v_mfma_f32_16x16x32_bf16 v[72:75], a[56:59], v[144:147], v[72:75]
ds_read_b128 a[8:11], v218 offset:32768
v_cvt_pk_bf16_f32 v154, v172, v173
v_mfma_f32_16x16x32_bf16 v[84:87], a[60:63], v[144:147], v[84:87]
v_exp_f32 v175, v119 clamp
v_mfma_f32_16x16x32_bf16 v[4:7], a[32:35], v[148:151], v[4:7]
buffer_load_dwordx4 v245, s[20:23], s47 offen offset:1024 nt lds
v_mfma_f32_16x16x32_bf16 v[16:19], a[36:39], v[148:151], v[16:19]
ds_read_b128 a[12:15], v219 offset:32768
v_cvt_pk_bf16_f32 v155, v174, v175
v_mfma_f32_16x16x32_bf16 v[28:31], a[40:43], v[148:151], v[28:31]
v_exp_f32 v168, v120 clamp
v_mfma_f32_16x16x32_bf16 v[184:187], a[64:67], v[152:155], v[184:187]
v_exp_f32 v169, v121 clamp
v_mfma_f32_16x16x32_bf16 v[40:43], a[44:47], v[148:151], v[40:43]
ds_read_b128 a[16:19], v216 offset:36864
v_cvt_pk_bf16_f32 v144, v168, v169
v_mfma_f32_16x16x32_bf16 v[52:55], a[48:51], v[148:151], v[52:55]
v_exp_f32 v170, v122 clamp
v_mfma_f32_16x16x32_bf16 v[64:67], a[52:55], v[148:151], v[64:67]
buffer_load_dwordx4 v244, s[20:23], s47 offen offset:2048 nt lds
v_mfma_f32_16x16x32_bf16 v[76:79], a[56:59], v[148:151], v[76:79]
v_exp_f32 v171, v123 clamp
v_cmp_ngt_f32 vcc, 1.0, v184
v_mfma_f32_16x16x32_bf16 v[88:91], a[60:63], v[148:151], v[88:91]
s_cbranch_vccnz L_rs_sa4_2
L_rs_sa4_2_ret:
ds_read_b128 a[20:23], v217 offset:36864
v_cvt_pk_bf16_f32 v145, v170, v171
v_mfma_f32_16x16x32_bf16 v[8:11], a[32:35], v[152:155], v[8:11]
v_exp_f32 v172, v124 clamp
v_mfma_f32_16x16x32_bf16 v[20:23], a[36:39], v[152:155], v[20:23]
v_exp_f32 v173, v125 clamp
v_mfma_f32_16x16x32_bf16 v[32:35], a[40:43], v[152:155], v[32:35]
ds_read_b128 a[24:27], v218 offset:36864
v_cvt_pk_bf16_f32 v146, v172, v173
v_mfma_f32_16x16x32_bf16 v[44:47], a[44:47], v[152:155], v[44:47]
buffer_load_dwordx4 v245, s[20:23], s47 offen offset:3072 nt lds
s_add_u32 s47, s47, 16384
v_mfma_f32_16x16x32_bf16 v[56:59], a[48:51], v[152:155], v[56:59]
ds_read_b128 a[28:31], v219 offset:36864
v_mfma_f32_16x16x32_bf16 v[68:71], a[52:55], v[152:155], v[68:71]
v_exp_f32 v174, v126 clamp
v_mfma_f32_16x16x32_bf16 v[80:83], a[56:59], v[152:155], v[80:83]
v_exp_f32 v175, v127 clamp
v_mfma_f32_16x16x32_bf16 v[92:95], a[60:63], v[152:155], v[92:95]
s_waitcnt lgkmcnt(1)
v_cvt_pk_bf16_f32 v147, v174, v175
s_branch L_join
L_plain2:
buffer_load_dwordx4 v[188:191], v241, s[32:35], s92 offen offset:0 sc1
buffer_load_dwordx4 v[192:195], v241, s[32:35], s92 offen offset:1024 sc1
buffer_load_dwordx4 v[196:199], v241, s[32:35], s92 offen offset:2048 sc1
buffer_load_dwordx4 v[200:203], v241, s[32:35], s92 offen offset:3072 sc1
buffer_load_dwordx4 v[204:207], v241, s[32:35], s93 offen offset:0 sc1
buffer_load_dwordx4 v[208:211], v241, s[32:35], s93 offen offset:1024 sc1
buffer_load_dwordx2 v[212:213], v228, s[32:35], s93 offen offset:2048 sc1
s_waitcnt lgkmcnt(0)
s_barrier
ds_read_b128 v[100:103], v229 offset:6144
ds_read_b128 a[0:3], v229 offset:0
ds_read_b128 a[4:7], v229 offset:1024
ds_read_b128 a[8:11], v229 offset:2048
ds_read_b128 a[12:15], v229 offset:3072
ds_read_b128 a[16:19], v229 offset:4096
ds_read_b128 a[20:23], v229 offset:5120
s_branch L_plain3
L_roleB:
s_waitcnt vmcnt(0)
v_add3_u32 v230, v254, v212, v188
v_add3_u32 v231, v189, v190, v191
v_add3_u32 v230, v230, v192, v193
v_add3_u32 v231, v231, v194, v195
v_add3_u32 v230, v230, v196, v197
v_add3_u32 v231, v231, v198, v199
v_add3_u32 v230, v230, v200, v201
v_add3_u32 v231, v231, v202, v203
v_add3_u32 v230, v230, v204, v205
v_add3_u32 v231, v231, v206, v207
v_add3_u32 v230, v230, v208, v209
v_add3_u32 v231, v231, v210, v211
v_add_u32 v230, v230, v231
v_cmp_ne_u32 vcc, v230, v213
v_readlane_b32 s66, v212, 63
L_val_done:
s_cbranch_vccnz L_retry
s_bitcmp1_b32 s66, 0
s_cbranch_scc1 L_slow2a
v_add_f32 v236, v96, v212
v_add_f32 v237, v236, v100
v_rcp_f32 v236, v237
v_mfma_f32_16x16x32_bf16 v[0:3], a[72:75], v[188:191], v[0:3]
v_mov_b32 v237, v236
s_nop 0
v_mfma_f32_16x16x32_bf16 v[12:15], a[76:79], v[188:191], v[12:15]
v_permlane16_swap_b32 v236, v237
s_nop 0
v_mfma_f32_16x16x32_bf16 v[24:27], a[72:75], v[192:195], v[24:27]
v_mov_b32 v238, v236
v_mov_b32 v239, v237
v_mfma_f32_16x16x32_bf16 v[36:39], a[76:79], v[192:195], v[36:39]
s_nop 0
v_permlane32_swap_b32 v236, v238
v_mfma_f32_16x16x32_bf16 v[4:7], a[72:75], v[196:199], v[4:7]
v_permlane32_swap_b32 v237, v239
s_add_u32 s66, s44, 4096
v_mfma_f32_16x16x32_bf16 v[16:19], a[76:79], v[196:199], v[16:19]
s_add_u32 s67, s44, 8192
v_mfma_f32_16x16x32_bf16 v[28:31], a[72:75], v[200:203], v[28:31]
v_mfma_f32_16x16x32_bf16 v[40:43], a[76:79], v[200:203], v[40:43]
v_mfma_f32_16x16x32_bf16 v[8:11], a[72:75], v[204:207], v[8:11]
v_mfma_f32_16x16x32_bf16 v[20:23], a[76:79], v[204:207], v[20:23]
v_mfma_f32_16x16x32_bf16 v[32:35], a[72:75], v[208:211], v[32:35]
v_mfma_f32_16x16x32_bf16 v[44:47], a[76:79], v[208:211], v[44:47]
v_mfma_f32_16x16x32_bf16 v[0:3], a[72:75], a[0:3], v[0:3]
v_mfma_f32_16x16x32_bf16 v[12:15], a[76:79], a[0:3], v[12:15]
v_mfma_f32_16x16x32_bf16 v[24:27], a[72:75], a[4:7], v[24:27]
v_mfma_f32_16x16x32_bf16 v[36:39], a[76:79], a[4:7], v[36:39]
v_mfma_f32_16x16x32_bf16 v[4:7], a[72:75], a[8:11], v[4:7]
s_nop 3
v_pk_mul_f32 v[0:1], v[0:1], v[236:237] op_sel:[0,0] op_sel_hi:[1,0]
v_pk_mul_f32 v[2:3], v[2:3], v[236:237] op_sel:[0,0] op_sel_hi:[1,0]
v_cvt_pk_bf16_f32 v0, v0, v1
v_mfma_f32_16x16x32_bf16 v[16:19], a[76:79], a[8:11], v[16:19]
v_cvt_pk_bf16_f32 v1, v2, v3
ds_write_b64 v253, v[0:1] offset:0
v_pk_mul_f32 v[12:13], v[12:13], v[236:237] op_sel:[0,0] op_sel_hi:[1,0]
v_mfma_f32_16x16x32_bf16 v[28:31], a[72:75], a[12:15], v[28:31]
v_pk_mul_f32 v[14:15], v[14:15], v[236:237] op_sel:[0,0] op_sel_hi:[1,0]
v_cvt_pk_bf16_f32 v12, v12, v13
v_cvt_pk_bf16_f32 v13, v14, v15
v_mfma_f32_16x16x32_bf16 v[40:43], a[76:79], a[12:15], v[40:43]
ds_write_b64 v217, v[12:13] offset:0
v_pk_mul_f32 v[24:25], v[24:25], v[236:237] op_sel:[0,0] op_sel_hi:[1,0]
v_pk_mul_f32 v[26:27], v[26:27], v[236:237] op_sel:[0,0] op_sel_hi:[1,0]
v_mfma_f32_16x16x32_bf16 v[8:11], a[72:75], a[16:19], v[8:11]
v_cvt_pk_bf16_f32 v24, v24, v25
v_cvt_pk_bf16_f32 v25, v26, v27
ds_write_b64 v218, v[24:25] offset:0
v_mfma_f32_16x16x32_bf16 v[20:23], a[76:79], a[16:19], v[20:23]
v_pk_mul_f32 v[36:37], v[36:37], v[236:237] op_sel:[0,0] op_sel_hi:[1,0]
v_pk_mul_f32 v[38:39], v[38:39], v[236:237] op_sel:[0,0] op_sel_hi:[1,0]
v_cvt_pk_bf16_f32 v36, v36, v37
v_mfma_f32_16x16x32_bf16 v[32:35], a[72:75], a[20:23], v[32:35]
v_cvt_pk_bf16_f32 v37, v38, v39
ds_write_b64 v219, v[36:37] offset:0
ds_read_b128 v[120:123], v252 offset:0
v_mfma_f32_16x16x32_bf16 v[44:47], a[76:79], a[20:23], v[44:47]
ds_read_b128 v[124:127], v252 offset:1024
s_branch L_out12
L_slow2a:
v_mfma_f32_16x16x32_bf16 v[0:3], a[72:75], a[0:3], v[0:3]
v_mfma_f32_16x16x32_bf16 v[12:15], a[76:79], a[0:3], v[12:15]
v_mfma_f32_16x16x32_bf16 v[24:27], a[72:75], a[4:7], v[24:27]
v_mfma_f32_16x16x32_bf16 v[36:39], a[76:79], a[4:7], v[36:39]
v_mfma_f32_16x16x32_bf16 v[4:7], a[72:75], a[8:11], v[4:7]
v_mfma_f32_16x16x32_bf16 v[16:19], a[76:79], a[8:11], v[16:19]
v_mfma_f32_16x16x32_bf16 v[28:31], a[72:75], a[12:15], v[28:31]
v_mfma_f32_16x16x32_bf16 v[40:43], a[76:79], a[12:15], v[40:43]
v_mfma_f32_16x16x32_bf16 v[8:11], a[72:75], a[16:19], v[8:11]
v_mfma_f32_16x16x32_bf16 v[20:23], a[76:79], a[16:19], v[20:23]
v_mfma_f32_16x16x32_bf16 v[32:35], a[72:75], a[20:23], v[32:35]
v_mfma_f32_16x16x32_bf16 v[44:47], a[76:79], a[20:23], v[44:47]
s_branch L_slow2
L_retry:
L_wt_r:
buffer_load_dword v255, v242, s[32:35], s80 offen offset:2552 sc1
s_sub_u32 s51, s51, 1
s_cbranch_scc1 L_end
s_waitcnt vmcnt(0)
v_and_b32 v255, -2, v255
v_cmp_ne_u32 vcc, v255, v254
s_nop 0
s_cbranch_vccnz L_wt_r
buffer_load_dwordx4 v[188:191], v241, s[32:35], s92 offen offset:0 sc1
buffer_load_dwordx4 v[192:195], v241, s[32:35], s92 offen offset:1024 sc1
buffer_load_dwordx4 v[196:199], v241, s[32:35], s92 offen offset:2048 sc1
buffer_load_dwordx4 v[200:203], v241, s[32:35], s92 offen offset:3072 sc1
buffer_load_dwordx4 v[204:207], v241, s[32:35], s93 offen offset:0 sc1
buffer_load_dwordx4 v[208:211], v241, s[32:35], s93 offen offset:1024 sc1
buffer_load_dwordx2 v[212:213], v228, s[32:35], s93 offen offset:2048 sc1
s_sub_u32 s51, s51, 1
s_cbranch_scc1 L_end
s_waitcnt vmcnt(0)
v_add3_u32 v230, v254, v212, v188
v_add3_u32 v231, v189, v190, v191
v_add3_u32 v230, v230, v192, v193
v_add3_u32 v231, v231, v194, v195
v_add3_u32 v230, v230, v196, v197
v_add3_u32 v231, v231, v198, v199
v_add3_u32 v230, v230, v200, v201
v_add3_u32 v231, v231, v202, v203
v_add3_u32 v230, v230, v204, v205
v_add3_u32 v231, v231, v206, v207
v_add3_u32 v230, v230, v208, v209
v_add3_u32 v231, v231, v210, v211
v_add_u32 v230, v230, v231
v_cmp_ne_u32 vcc, v230, v213
v_readlane_b32 s66, v212, 63
s_branch L_val_done
L_nonwait:
buffer_load_dword v254, v242, s[36:39], 0 offen sc1
s_sub_u32 s51, s51, 1
s_cbranch_scc1 L_end
s_waitcnt vmcnt(0)
v_cmp_eq_u32 vcc, 0, v254
s_nop 0
s_cbranch_vccz L_havenon
s_sleep 8
s_branch L_nonwait
L_slow1:
s_nop 7
v_mov_b32 v236, v96
v_min_f32 v235, v156, v101
v_sub_f32 v144, v235, v156
v_sub_f32 v145, v235, v101
v_exp_f32 v144, v144
v_exp_f32 v145, v145
v_mov_b32 v156, v235
v_mov_b32 v148, v144
v_mov_b32 v149, v145
v_mul_f32 v0, v0, v144
v_mul_f32 v1, v1, v144
v_mul_f32 v2, v2, v144
v_mul_f32 v3, v3, v144
v_mul_f32 v12, v12, v144
v_mul_f32 v13, v13, v144
v_mul_f32 v14, v14, v144
v_mul_f32 v15, v15, v144
v_mul_f32 v24, v24, v144
v_mul_f32 v25, v25, v144
v_mul_f32 v26, v26, v144
v_mul_f32 v27, v27, v144
v_mul_f32 v36, v36, v144
v_mul_f32 v37, v37, v144
v_mul_f32 v38, v38, v144
v_mul_f32 v39, v39, v144
v_accvgpr_read_b32 v233, a0
v_lshlrev_b32 v232, 16, v233
v_and_b32 v233, s71, v233
v_fmac_f32 v0, v232, v145
v_fmac_f32 v1, v233, v145
v_accvgpr_read_b32 v233, a1
v_lshlrev_b32 v232, 16, v233
v_and_b32 v233, s71, v233
v_fmac_f32 v2, v232, v145
v_fmac_f32 v3, v233, v145
v_accvgpr_read_b32 v233, a2
v_lshlrev_b32 v232, 16, v233
v_and_b32 v233, s71, v233
v_fmac_f32 v12, v232, v145
v_fmac_f32 v13, v233, v145
v_accvgpr_read_b32 v233, a3
v_lshlrev_b32 v232, 16, v233
v_and_b32 v233, s71, v233
v_fmac_f32 v14, v232, v145
v_fmac_f32 v15, v233, v145
v_accvgpr_read_b32 v233, a4
v_lshlrev_b32 v232, 16, v233
v_and_b32 v233, s71, v233
v_fmac_f32 v24, v232, v145
v_fmac_f32 v25, v233, v145
v_accvgpr_read_b32 v233, a5
v_lshlrev_b32 v232, 16, v233
v_and_b32 v233, s71, v233
v_fmac_f32 v26, v232, v145
v_fmac_f32 v27, v233, v145
v_accvgpr_read_b32 v233, a6
v_lshlrev_b32 v232, 16, v233
v_and_b32 v233, s71, v233
v_fmac_f32 v36, v232, v145
v_fmac_f32 v37, v233, v145
v_accvgpr_read_b32 v233, a7
v_lshlrev_b32 v232, 16, v233
v_and_b32 v233, s71, v233
v_fmac_f32 v38, v232, v145
v_fmac_f32 v39, v233, v145
v_min_f32 v235, v160, v102
v_sub_f32 v144, v235, v160
v_sub_f32 v145, v235, v102
v_exp_f32 v144, v144
v_exp_f32 v145, v145
v_mov_b32 v160, v235
v_cndmask_b32 v148, v148, v144, s[60:61]
v_cndmask_b32 v149, v149, v145, s[60:61]
v_mul_f32 v4, v4, v144
v_mul_f32 v5, v5, v144
v_mul_f32 v6, v6, v144
v_mul_f32 v7, v7, v144
v_mul_f32 v16, v16, v144
v_mul_f32 v17, v17, v144
v_mul_f32 v18, v18, v144
v_mul_f32 v19, v19, v144
v_mul_f32 v28, v28, v144
v_mul_f32 v29, v29, v144
v_mul_f32 v30, v30, v144
v_mul_f32 v31, v31, v144
v_mul_f32 v40, v40, v144
v_mul_f32 v41, v41, v144
v_mul_f32 v42, v42, v144
v_mul_f32 v43, v43, v144
v_accvgpr_read_b32 v233, a8
v_lshlrev_b32 v232, 16, v233
v_and_b32 v233, s71, v233
v_fmac_f32 v4, v232, v145
v_fmac_f32 v5, v233, v145
v_accvgpr_read_b32 v233, a9
v_lshlrev_b32 v232, 16, v233
v_and_b32 v233, s71, v233
v_fmac_f32 v6, v232, v145
v_fmac_f32 v7, v233, v145
v_accvgpr_read_b32 v233, a10
v_lshlrev_b32 v232, 16, v233
v_and_b32 v233, s71, v233
v_fmac_f32 v16, v232, v145
v_fmac_f32 v17, v233, v145
v_accvgpr_read_b32 v233, a11
v_lshlrev_b32 v232, 16, v233
v_and_b32 v233, s71, v233
v_fmac_f32 v18, v232, v145
v_fmac_f32 v19, v233, v145
v_accvgpr_read_b32 v233, a12
v_lshlrev_b32 v232, 16, v233
v_and_b32 v233, s71, v233
v_fmac_f32 v28, v232, v145
v_fmac_f32 v29, v233, v145
v_accvgpr_read_b32 v233, a13
v_lshlrev_b32 v232, 16, v233
v_and_b32 v233, s71, v233
v_fmac_f32 v30, v232, v145
v_fmac_f32 v31, v233, v145
v_accvgpr_read_b32 v233, a14
v_lshlrev_b32 v232, 16, v233
v_and_b32 v233, s71, v233
v_fmac_f32 v40, v232, v145
v_fmac_f32 v41, v233, v145
v_accvgpr_read_b32 v233, a15
v_lshlrev_b32 v232, 16, v233
v_and_b32 v233, s71, v233
v_fmac_f32 v42, v232, v145
v_fmac_f32 v43, v233, v145
v_min_f32 v235, v164, v103
v_sub_f32 v144, v235, v164
v_sub_f32 v145, v235, v103
v_exp_f32 v144, v144
v_exp_f32 v145, v145
v_mov_b32 v164, v235
v_cndmask_b32 v148, v148, v144, s[62:63]
v_cndmask_b32 v149, v149, v145, s[62:63]
v_mul_f32 v8, v8, v144
v_mul_f32 v9, v9, v144
v_mul_f32 v10, v10, v144
v_mul_f32 v11, v11, v144
v_mul_f32 v20, v20, v144
v_mul_f32 v21, v21, v144
v_mul_f32 v22, v22, v144
v_mul_f32 v23, v23, v144
v_mul_f32 v32, v32, v144
v_mul_f32 v33, v33, v144
v_mul_f32 v34, v34, v144
v_mul_f32 v35, v35, v144
v_mul_f32 v44, v44, v144
v_mul_f32 v45, v45, v144
v_mul_f32 v46, v46, v144
v_mul_f32 v47, v47, v144
v_accvgpr_read_b32 v233, a16
v_lshlrev_b32 v232, 16, v233
v_and_b32 v233, s71, v233
v_fmac_f32 v8, v232, v145
v_fmac_f32 v9, v233, v145
v_accvgpr_read_b32 v233, a17
v_lshlrev_b32 v232, 16, v233
v_and_b32 v233, s71, v233
v_fmac_f32 v10, v232, v145
v_fmac_f32 v11, v233, v145
v_accvgpr_read_b32 v233, a18
v_lshlrev_b32 v232, 16, v233
v_and_b32 v233, s71, v233
v_fmac_f32 v20, v232, v145
v_fmac_f32 v21, v233, v145
v_accvgpr_read_b32 v233, a19
v_lshlrev_b32 v232, 16, v233
v_and_b32 v233, s71, v233
v_fmac_f32 v22, v232, v145
v_fmac_f32 v23, v233, v145
v_accvgpr_read_b32 v233, a20
v_lshlrev_b32 v232, 16, v233
v_and_b32 v233, s71, v233
v_fmac_f32 v32, v232, v145
v_fmac_f32 v33, v233, v145
v_accvgpr_read_b32 v233, a21
v_lshlrev_b32 v232, 16, v233
v_and_b32 v233, s71, v233
v_fmac_f32 v34, v232, v145
v_fmac_f32 v35, v233, v145
v_accvgpr_read_b32 v233, a22
v_lshlrev_b32 v232, 16, v233
v_and_b32 v233, s71, v233
v_fmac_f32 v44, v232, v145
v_fmac_f32 v45, v233, v145
v_accvgpr_read_b32 v233, a23
v_lshlrev_b32 v232, 16, v233
v_and_b32 v233, s71, v233
v_fmac_f32 v46, v232, v145
v_fmac_f32 v47, v233, v145
v_mul_f32 v236, v236, v148
v_fmac_f32 v236, v100, v149
s_mov_b32 s50, 1
s_cmp_lg_u32 s41, 0
s_cbranch_scc1 L_slow1B
v_mov_b32 v104, v156
v_mov_b32 v105, v160
v_mov_b32 v106, v164
v_add3_u32 v107, v254, v104, v105
v_add_u32 v107, v107, v106
buffer_store_dwordx4 v[104:107], v241, s[32:35], s80 offen offset:3072 sc1
v_or_b32 v235, s50, v254
v_cndmask_b32 v96, v236, v235, s[64:65]
v_add_u32 v97, v96, v254
v_cvt_pk_bf16_f32 v0, v0, v1
v_cvt_pk_bf16_f32 v1, v2, v3
v_cvt_pk_bf16_f32 v2, v12, v13
v_cvt_pk_bf16_f32 v3, v14, v15
buffer_store_dwordx4 v[0:3], v241, s[32:35], s70 offen offset:0 sc1
v_add3_u32 v97, v97, v0, v1
v_add3_u32 v97, v97, v2, v3
v_cvt_pk_bf16_f32 v24, v24, v25
v_cvt_pk_bf16_f32 v25, v26, v27
v_cvt_pk_bf16_f32 v26, v36, v37
v_cvt_pk_bf16_f32 v27, v38, v39
buffer_store_dwordx4 v[24:27], v241, s[32:35], s70 offen offset:1024 sc1
v_add3_u32 v97, v97, v24, v25
v_add3_u32 v97, v97, v26, v27
s_branch L_pub12
L_slow3:
v_mfma_f32_16x16x32_bf16 v[8:11], a[72:75], v[204:207], v[8:11]
v_mfma_f32_16x16x32_bf16 v[20:23], a[76:79], v[204:207], v[20:23]
v_mfma_f32_16x16x32_bf16 v[32:35], a[72:75], v[208:211], v[32:35]
v_mfma_f32_16x16x32_bf16 v[44:47], a[76:79], v[208:211], v[44:47]
s_waitcnt lgkmcnt(0)
s_nop 7
v_min_f32 v235, v156, v101
v_sub_f32 v144, v235, v156
v_sub_f32 v145, v235, v101
v_exp_f32 v144, v144
v_exp_f32 v145, v145
v_mov_b32 v156, v235
v_mov_b32 v148, v144
v_mov_b32 v149, v145
v_mul_f32 v0, v0, v144
v_mul_f32 v1, v1, v144
v_mul_f32 v2, v2, v144
v_mul_f32 v3, v3, v144
v_mul_f32 v12, v12, v144
v_mul_f32 v13, v13, v144
v_mul_f32 v14, v14, v144
v_mul_f32 v15, v15, v144
v_mul_f32 v24, v24, v144
v_mul_f32 v25, v25, v144
v_mul_f32 v26, v26, v144
v_mul_f32 v27, v27, v144
v_mul_f32 v36, v36, v144
v_mul_f32 v37, v37, v144
v_mul_f32 v38, v38, v144
v_mul_f32 v39, v39, v144
v_accvgpr_read_b32 v233, a0
v_lshlrev_b32 v232, 16, v233
v_and_b32 v233, s71, v233
v_fmac_f32 v0, v232, v145
v_fmac_f32 v1, v233, v145
v_accvgpr_read_b32 v233, a1
v_lshlrev_b32 v232, 16, v233
v_and_b32 v233, s71, v233
v_fmac_f32 v2, v232, v145
v_fmac_f32 v3, v233, v145
v_accvgpr_read_b32 v233, a2
v_lshlrev_b32 v232, 16, v233
v_and_b32 v233, s71, v233
v_fmac_f32 v12, v232, v145
v_fmac_f32 v13, v233, v145
v_accvgpr_read_b32 v233, a3
v_lshlrev_b32 v232, 16, v233
v_and_b32 v233, s71, v233
v_fmac_f32 v14, v232, v145
v_fmac_f32 v15, v233, v145
v_accvgpr_read_b32 v233, a4
v_lshlrev_b32 v232, 16, v233
v_and_b32 v233, s71, v233
v_fmac_f32 v24, v232, v145
v_fmac_f32 v25, v233, v145
v_accvgpr_read_b32 v233, a5
v_lshlrev_b32 v232, 16, v233
v_and_b32 v233, s71, v233
v_fmac_f32 v26, v232, v145
v_fmac_f32 v27, v233, v145
v_accvgpr_read_b32 v233, a6
v_lshlrev_b32 v232, 16, v233
v_and_b32 v233, s71, v233
v_fmac_f32 v36, v232, v145
v_fmac_f32 v37, v233, v145
v_accvgpr_read_b32 v233, a7
v_lshlrev_b32 v232, 16, v233
v_and_b32 v233, s71, v233
v_fmac_f32 v38, v232, v145
v_fmac_f32 v39, v233, v145
v_min_f32 v235, v160, v102
v_sub_f32 v144, v235, v160
v_sub_f32 v145, v235, v102
v_exp_f32 v144, v144
v_exp_f32 v145, v145
v_mov_b32 v160, v235
v_cndmask_b32 v148, v148, v144, s[60:61]
v_cndmask_b32 v149, v149, v145, s[60:61]
v_mul_f32 v4, v4, v144
v_mul_f32 v5, v5, v144
v_mul_f32 v6, v6, v144
v_mul_f32 v7, v7, v144
v_mul_f32 v16, v16, v144
v_mul_f32 v17, v17, v144
v_mul_f32 v18, v18, v144
v_mul_f32 v19, v19, v144
v_mul_f32 v28, v28, v144
v_mul_f32 v29, v29, v144
v_mul_f32 v30, v30, v144
v_mul_f32 v31, v31, v144
v_mul_f32 v40, v40, v144
v_mul_f32 v41, v41, v144
v_mul_f32 v42, v42, v144
v_mul_f32 v43, v43, v144
v_accvgpr_read_b32 v233, a8
v_lshlrev_b32 v232, 16, v233
v_and_b32 v233, s71, v233
v_fmac_f32 v4, v232, v145
v_fmac_f32 v5, v233, v145
v_accvgpr_read_b32 v233, a9
v_lshlrev_b32 v232, 16, v233
v_and_b32 v233, s71, v233
v_fmac_f32 v6, v232, v145
v_fmac_f32 v7, v233, v145
v_accvgpr_read_b32 v233, a10
v_lshlrev_b32 v232, 16, v233
v_and_b32 v233, s71, v233
v_fmac_f32 v16, v232, v145
v_fmac_f32 v17, v233, v145
v_accvgpr_read_b32 v233, a11
v_lshlrev_b32 v232, 16, v233
v_and_b32 v233, s71, v233
v_fmac_f32 v18, v232, v145
v_fmac_f32 v19, v233, v145
v_accvgpr_read_b32 v233, a12
v_lshlrev_b32 v232, 16, v233
v_and_b32 v233, s71, v233
v_fmac_f32 v28, v232, v145
v_fmac_f32 v29, v233, v145
v_accvgpr_read_b32 v233, a13
v_lshlrev_b32 v232, 16, v233
v_and_b32 v233, s71, v233
v_fmac_f32 v30, v232, v145
v_fmac_f32 v31, v233, v145
v_accvgpr_read_b32 v233, a14
v_lshlrev_b32 v232, 16, v233
v_and_b32 v233, s71, v233
v_fmac_f32 v40, v232, v145
v_fmac_f32 v41, v233, v145
v_accvgpr_read_b32 v233, a15
v_lshlrev_b32 v232, 16, v233
v_and_b32 v233, s71, v233
v_fmac_f32 v42, v232, v145
v_fmac_f32 v43, v233, v145
v_min_f32 v235, v164, v103
v_sub_f32 v144, v235, v164
v_sub_f32 v145, v235, v103
v_exp_f32 v144, v144
v_exp_f32 v145, v145
v_mov_b32 v164, v235
v_cndmask_b32 v148, v148, v144, s[62:63]
v_cndmask_b32 v149, v149, v145, s[62:63]
v_mul_f32 v8, v8, v144
v_mul_f32 v9, v9, v144
v_mul_f32 v10, v10, v144
v_mul_f32 v11, v11, v144
v_mul_f32 v20, v20, v144
v_mul_f32 v21, v21, v144
v_mul_f32 v22, v22, v144
v_mul_f32 v23, v23, v144
v_mul_f32 v32, v32, v144
v_mul_f32 v33, v33, v144
v_mul_f32 v34, v34, v144
v_mul_f32 v35, v35, v144
v_mul_f32 v44, v44, v144
v_mul_f32 v45, v45, v144
v_mul_f32 v46, v46, v144
v_mul_f32 v47, v47, v144
v_accvgpr_read_b32 v233, a16
v_lshlrev_b32 v232, 16, v233
v_and_b32 v233, s71, v233
v_fmac_f32 v8, v232, v145
v_fmac_f32 v9, v233, v145
v_accvgpr_read_b32 v233, a17
v_lshlrev_b32 v232, 16, v233
v_and_b32 v233, s71, v233
v_fmac_f32 v10, v232, v145
v_fmac_f32 v11, v233, v145
v_accvgpr_read_b32 v233, a18
v_lshlrev_b32 v232, 16, v233
v_and_b32 v233, s71, v233
v_fmac_f32 v20, v232, v145
v_fmac_f32 v21, v233, v145
v_accvgpr_read_b32 v233, a19
v_lshlrev_b32 v232, 16, v233
v_and_b32 v233, s71, v233
v_fmac_f32 v22, v232, v145
v_fmac_f32 v23, v233, v145
v_accvgpr_read_b32 v233, a20
v_lshlrev_b32 v232, 16, v233
v_and_b32 v233, s71, v233
v_fmac_f32 v32, v232, v145
v_fmac_f32 v33, v233, v145
v_accvgpr_read_b32 v233, a21
v_lshlrev_b32 v232, 16, v233
v_and_b32 v233, s71, v233
v_fmac_f32 v34, v232, v145
v_fmac_f32 v35, v233, v145
v_accvgpr_read_b32 v233, a22
v_lshlrev_b32 v232, 16, v233
v_and_b32 v233, s71, v233
v_fmac_f32 v44, v232, v145
v_fmac_f32 v45, v233, v145
v_accvgpr_read_b32 v233, a23
v_lshlrev_b32 v232, 16, v233
v_and_b32 v233, s71, v233
v_fmac_f32 v46, v232, v145
v_fmac_f32 v47, v233, v145
v_mul_f32 v236, v236, v148
v_fmac_f32 v236, v100, v149
v_rcp_f32 v236, v236
s_nop 0
v_mov_b32 v237, v236
s_nop 0
s_nop 0
v_permlane16_swap_b32 v236, v237
s_nop 0
v_mov_b32 v238, v236
v_mov_b32 v239, v237
s_nop 0
v_permlane32_swap_b32 v236, v238
v_permlane32_swap_b32 v237, v239
s_add_u32 s66, s44, 4096
s_add_u32 s67, s44, 8192
v_pk_mul_f32 v[0:1], v[0:1], v[236:237] op_sel:[0,0] op_sel_hi:[1,0]
v_pk_mul_f32 v[2:3], v[2:3], v[236:237] op_sel:[0,0] op_sel_hi:[1,0]
v_cvt_pk_bf16_f32 v0, v0, v1
v_cvt_pk_bf16_f32 v1, v2, v3
ds_write_b64 v253, v[0:1] offset:0
v_pk_mul_f32 v[12:13], v[12:13], v[236:237] op_sel:[0,0] op_sel_hi:[1,0]
v_pk_mul_f32 v[14:15], v[14:15], v[236:237] op_sel:[0,0] op_sel_hi:[1,0]
v_cvt_pk_bf16_f32 v12, v12, v13
v_cvt_pk_bf16_f32 v13, v14, v15
ds_write_b64 v217, v[12:13] offset:0
v_pk_mul_f32 v[24:25], v[24:25], v[236:237] op_sel:[0,0] op_sel_hi:[1,0]
v_pk_mul_f32 v[26:27], v[26:27], v[236:237] op_sel:[0,0] op_sel_hi:[1,0]
v_cvt_pk_bf16_f32 v24, v24, v25
v_cvt_pk_bf16_f32 v25, v26, v27
ds_write_b64 v218, v[24:25] offset:0
v_pk_mul_f32 v[36:37], v[36:37], v[236:237] op_sel:[0,0] op_sel_hi:[1,0]
v_pk_mul_f32 v[38:39], v[38:39], v[236:237] op_sel:[0,0] op_sel_hi:[1,0]
v_cvt_pk_bf16_f32 v36, v36, v37
v_cvt_pk_bf16_f32 v37, v38, v39
ds_write_b64 v219, v[36:37] offset:0
ds_read_b128 v[120:123], v252 offset:0
ds_read_b128 v[124:127], v252 offset:1024
s_branch L_out12
L_slow1B:
L_s1v:
s_waitcnt vmcnt(0)
v_add3_u32 v230, v254, v212, v188
v_add3_u32 v231, v189, v190, v191
v_add3_u32 v230, v230, v192, v193
v_add3_u32 v231, v231, v194, v195
v_add3_u32 v230, v230, v196, v197
v_add3_u32 v231, v231, v198, v199
v_add3_u32 v230, v230, v200, v201
v_add3_u32 v231, v231, v202, v203
v_add3_u32 v230, v230, v204, v205
v_add3_u32 v231, v231, v206, v207
v_add3_u32 v230, v230, v208, v209
v_add3_u32 v231, v231, v210, v211
v_add_u32 v230, v230, v231
v_cmp_ne_u32 vcc, v230, v213
v_readlane_b32 s66, v212, 63
s_cbranch_vccz L_slow2
L_wt_s:
buffer_load_dword v255, v242, s[32:35], s80 offen offset:2552 sc1
s_sub_u32 s51, s51, 1
s_cbranch_scc1 L_end
s_waitcnt vmcnt(0)
v_and_b32 v255, -2, v255
v_cmp_ne_u32 vcc, v255, v254
s_nop 0
s_cbranch_vccnz L_wt_s
buffer_load_dwordx4 v[188:191], v241, s[32:35], s92 offen offset:0 sc1
buffer_load_dwordx4 v[192:195], v241, s[32:35], s92 offen offset:1024 sc1
buffer_load_dwordx4 v[196:199], v241, s[32:35], s92 offen offset:2048 sc1
buffer_load_dwordx4 v[200:203], v241, s[32:35], s92 offen offset:3072 sc1
buffer_load_dwordx4 v[204:207], v241, s[32:35], s93 offen offset:0 sc1
buffer_load_dwordx4 v[208:211], v241, s[32:35], s93 offen offset:1024 sc1
buffer_load_dwordx2 v[212:213], v228, s[32:35], s93 offen offset:2048 sc1
s_sub_u32 s51, s51, 1
s_cbranch_scc1 L_end
s_branch L_s1v
L_slow2:
s_nop 7
v_mov_b32 v104, v248
v_mov_b32 v105, v249
v_mov_b32 v106, v250
s_bitcmp1_b32 s66, 0
s_cbranch_scc0 L_nm_ok
L_nm:
buffer_load_dwordx4 v[104:107], v241, s[32:35], s80 offen offset:3072 sc1
s_sub_u32 s51, s51, 1
s_cbranch_scc1 L_end
s_waitcnt vmcnt(0)
v_add3_u32 v232, v254, v104, v105
v_add_u32 v232, v232, v106
v_cmp_ne_u32 vcc, v232, v107
s_nop 0
s_cbranch_vccnz L_nm
L_nm_ok:
v_min_f32 v235, v156, v104
v_sub_f32 v144, v235, v156
v_sub_f32 v145, v235, v104
v_exp_f32 v144, v144
v_exp_f32 v145, v145
v_mov_b32 v156, v235
v_mov_b32 v148, v144
v_mov_b32 v149, v145
v_mul_f32 v0, v0, v144
v_mul_f32 v1, v1, v144
v_mul_f32 v2, v2, v144
v_mul_f32 v3, v3, v144
v_mul_f32 v12, v12, v144
v_mul_f32 v13, v13, v144
v_mul_f32 v14, v14, v144
v_mul_f32 v15, v15, v144
v_mul_f32 v24, v24, v144
v_mul_f32 v25, v25, v144
v_mul_f32 v26, v26, v144
v_mul_f32 v27, v27, v144
v_mul_f32 v36, v36, v144
v_mul_f32 v37, v37, v144
v_mul_f32 v38, v38, v144
v_mul_f32 v39, v39, v144
v_mov_b32 v233, v188
v_lshlrev_b32 v232, 16, v233
v_and_b32 v233, s71, v233
v_fmac_f32 v0, v232, v145
v_fmac_f32 v1, v233, v145
v_mov_b32 v233, v189
v_lshlrev_b32 v232, 16, v233
v_and_b32 v233, s71, v233
v_fmac_f32 v2, v232, v145
v_fmac_f32 v3, v233, v145
v_mov_b32 v233, v190
v_lshlrev_b32 v232, 16, v233
v_and_b32 v233, s71, v233
v_fmac_f32 v12, v232, v145
v_fmac_f32 v13, v233, v145
v_mov_b32 v233, v191
v_lshlrev_b32 v232, 16, v233
v_and_b32 v233, s71, v233
v_fmac_f32 v14, v232, v145
v_fmac_f32 v15, v233, v145
v_mov_b32 v233, v192
v_lshlrev_b32 v232, 16, v233
v_and_b32 v233, s71, v233
v_fmac_f32 v24, v232, v145
v_fmac_f32 v25, v233, v145
v_mov_b32 v233, v193
v_lshlrev_b32 v232, 16, v233
v_and_b32 v233, s71, v233
v_fmac_f32 v26, v232, v145
v_fmac_f32 v27, v233, v145
v_mov_b32 v233, v194
v_lshlrev_b32 v232, 16, v233
v_and_b32 v233, s71, v233
v_fmac_f32 v36, v232, v145
v_fmac_f32 v37, v233, v145
v_mov_b32 v233, v195
v_lshlrev_b32 v232, 16, v233
v_and_b32 v233, s71, v233
v_fmac_f32 v38, v232, v145
v_fmac_f32 v39, v233, v145
v_min_f32 v235, v160, v105
v_sub_f32 v144, v235, v160
v_sub_f32 v145, v235, v105
v_exp_f32 v144, v144
v_exp_f32 v145, v145
v_mov_b32 v160, v235
v_cndmask_b32 v148, v148, v144, s[60:61]
v_cndmask_b32 v149, v149, v145, s[60:61]
v_mul_f32 v4, v4, v144
v_mul_f32 v5, v5, v144
v_mul_f32 v6, v6, v144
v_mul_f32 v7, v7, v144
v_mul_f32 v16, v16, v144
v_mul_f32 v17, v17, v144
v_mul_f32 v18, v18, v144
v_mul_f32 v19, v19, v144
v_mul_f32 v28, v28, v144
v_mul_f32 v29, v29, v144
v_mul_f32 v30, v30, v144
v_mul_f32 v31, v31, v144
v_mul_f32 v40, v40, v144
v_mul_f32 v41, v41, v144
v_mul_f32 v42, v42, v144
v_mul_f32 v43, v43, v144
v_mov_b32 v233, v196
v_lshlrev_b32 v232, 16, v233
v_and_b32 v233, s71, v233
v_fmac_f32 v4, v232, v145
v_fmac_f32 v5, v233, v145
v_mov_b32 v233, v197
v_lshlrev_b32 v232, 16, v233
v_and_b32 v233, s71, v233
v_fmac_f32 v6, v232, v145
v_fmac_f32 v7, v233, v145
v_mov_b32 v233, v198
v_lshlrev_b32 v232, 16, v233
v_and_b32 v233, s71, v233
v_fmac_f32 v16, v232, v145
v_fmac_f32 v17, v233, v145
v_mov_b32 v233, v199
v_lshlrev_b32 v232, 16, v233
v_and_b32 v233, s71, v233
v_fmac_f32 v18, v232, v145
v_fmac_f32 v19, v233, v145
v_mov_b32 v233, v200
v_lshlrev_b32 v232, 16, v233
v_and_b32 v233, s71, v233
v_fmac_f32 v28, v232, v145
v_fmac_f32 v29, v233, v145
v_mov_b32 v233, v201
v_lshlrev_b32 v232, 16, v233
v_and_b32 v233, s71, v233
v_fmac_f32 v30, v232, v145
v_fmac_f32 v31, v233, v145
v_mov_b32 v233, v202
v_lshlrev_b32 v232, 16, v233
v_and_b32 v233, s71, v233
v_fmac_f32 v40, v232, v145
v_fmac_f32 v41, v233, v145
v_mov_b32 v233, v203
v_lshlrev_b32 v232, 16, v233
v_and_b32 v233, s71, v233
v_fmac_f32 v42, v232, v145
v_fmac_f32 v43, v233, v145
v_min_f32 v235, v164, v106
v_sub_f32 v144, v235, v164
v_sub_f32 v145, v235, v106
v_exp_f32 v144, v144
v_exp_f32 v145, v145
v_mov_b32 v164, v235
v_cndmask_b32 v148, v148, v144, s[62:63]
v_cndmask_b32 v149, v149, v145, s[62:63]
v_mul_f32 v8, v8, v144
v_mul_f32 v9, v9, v144
v_mul_f32 v10, v10, v144
v_mul_f32 v11, v11, v144
v_mul_f32 v20, v20, v144
v_mul_f32 v21, v21, v144
v_mul_f32 v22, v22, v144
v_mul_f32 v23, v23, v144
v_mul_f32 v32, v32, v144
v_mul_f32 v33, v33, v144
v_mul_f32 v34, v34, v144
v_mul_f32 v35, v35, v144
v_mul_f32 v44, v44, v144
v_mul_f32 v45, v45, v144
v_mul_f32 v46, v46, v144
v_mul_f32 v47, v47, v144
v_mov_b32 v233, v204
v_lshlrev_b32 v232, 16, v233
v_and_b32 v233, s71, v233
v_fmac_f32 v8, v232, v145
v_fmac_f32 v9, v233, v145
v_mov_b32 v233, v205
v_lshlrev_b32 v232, 16, v233
v_and_b32 v233, s71, v233
v_fmac_f32 v10, v232, v145
v_fmac_f32 v11, v233, v145
v_mov_b32 v233, v206
v_lshlrev_b32 v232, 16, v233
v_and_b32 v233, s71, v233
v_fmac_f32 v20, v232, v145
v_fmac_f32 v21, v233, v145
v_mov_b32 v233, v207
v_lshlrev_b32 v232, 16, v233
v_and_b32 v233, s71, v233
v_fmac_f32 v22, v232, v145
v_fmac_f32 v23, v233, v145
v_mov_b32 v233, v208
v_lshlrev_b32 v232, 16, v233
v_and_b32 v233, s71, v233
v_fmac_f32 v32, v232, v145
v_fmac_f32 v33, v233, v145
v_mov_b32 v233, v209
v_lshlrev_b32 v232, 16, v233
v_and_b32 v233, s71, v233
v_fmac_f32 v34, v232, v145
v_fmac_f32 v35, v233, v145
v_mov_b32 v233, v210
v_lshlrev_b32 v232, 16, v233
v_and_b32 v233, s71, v233
v_fmac_f32 v44, v232, v145
v_fmac_f32 v45, v233, v145
v_mov_b32 v233, v211
v_lshlrev_b32 v232, 16, v233
v_and_b32 v233, s71, v233
v_fmac_f32 v46, v232, v145
v_fmac_f32 v47, v233, v145
v_mul_f32 v236, v236, v148
v_fmac_f32 v236, v212, v149
v_rcp_f32 v236, v236
s_nop 0
v_mov_b32 v237, v236
s_nop 0
s_nop 0
v_permlane16_swap_b32 v236, v237
s_nop 0
v_mov_b32 v238, v236
v_mov_b32 v239, v237
s_nop 0
v_permlane32_swap_b32 v236, v238
v_permlane32_swap_b32 v237, v239
s_add_u32 s66, s44, 4096
s_add_u32 s67, s44, 8192
v_pk_mul_f32 v[0:1], v[0:1], v[236:237] op_sel:[0,0] op_sel_hi:[1,0]
v_pk_mul_f32 v[2:3], v[2:3], v[236:237] op_sel:[0,0] op_sel_hi:[1,0]
v_cvt_pk_bf16_f32 v0, v0, v1
v_cvt_pk_bf16_f32 v1, v2, v3
ds_write_b64 v253, v[0:1] offset:0
v_pk_mul_f32 v[12:13], v[12:13], v[236:237] op_sel:[0,0] op_sel_hi:[1,0]
v_pk_mul_f32 v[14:15], v[14:15], v[236:237] op_sel:[0,0] op_sel_hi:[1,0]
v_cvt_pk_bf16_f32 v12, v12, v13
v_cvt_pk_bf16_f32 v13, v14, v15
ds_write_b64 v217, v[12:13] offset:0
v_pk_mul_f32 v[24:25], v[24:25], v[236:237] op_sel:[0,0] op_sel_hi:[1,0]
v_pk_mul_f32 v[26:27], v[26:27], v[236:237] op_sel:[0,0] op_sel_hi:[1,0]
v_cvt_pk_bf16_f32 v24, v24, v25
v_cvt_pk_bf16_f32 v25, v26, v27
ds_write_b64 v218, v[24:25] offset:0
v_pk_mul_f32 v[36:37], v[36:37], v[236:237] op_sel:[0,0] op_sel_hi:[1,0]
v_pk_mul_f32 v[38:39], v[38:39], v[236:237] op_sel:[0,0] op_sel_hi:[1,0]
v_cvt_pk_bf16_f32 v36, v36, v37
v_cvt_pk_bf16_f32 v37, v38, v39
ds_write_b64 v219, v[36:37] offset:0
ds_read_b128 v[120:123], v252 offset:0
ds_read_b128 v[124:127], v252 offset:1024
s_branch L_out12
L_rs_sa0_0:
s_call_b64 s[52:53], L_rescale_0_0
s_branch L_rs_sa0_0_ret
L_rs_sa0_1:
s_call_b64 s[52:53], L_rescale_1_0
s_branch L_rs_sa0_1_ret
L_rs_sa0_2:
s_call_b64 s[52:53], L_rescale_2_0
s_branch L_rs_sa0_2_ret
L_rs_sa1_0:
s_call_b64 s[52:53], L_rescale_0_1
s_branch L_rs_sa1_0_ret
L_rs_sa1_1:
s_call_b64 s[52:53], L_rescale_1_1
s_branch L_rs_sa1_1_ret
L_rs_sa1_2:
s_call_b64 s[52:53], L_rescale_2_1
s_branch L_rs_sa1_2_ret
L_rs_sa2_0:
s_call_b64 s[52:53], L_rescale_0_0
s_branch L_rs_sa2_0_ret
L_rs_sa2_1:
s_call_b64 s[52:53], L_rescale_1_0
s_branch L_rs_sa2_1_ret
L_rs_sa2_2:
s_call_b64 s[52:53], L_rescale_2_0
s_branch L_rs_sa2_2_ret
L_rs_sa3_0:
s_call_b64 s[52:53], L_rescale_0_1
s_branch L_rs_sa3_0_ret
L_rs_sa3_1:
s_call_b64 s[52:53], L_rescale_1_1
s_branch L_rs_sa3_1_ret
L_rs_sa3_2:
s_call_b64 s[52:53], L_rescale_2_1
s_branch L_rs_sa3_2_ret
L_rs_sa4_0:
s_call_b64 s[52:53], L_rescale_0_0
s_branch L_rs_sa4_0_ret
L_rs_sa4_1:
s_call_b64 s[52:53], L_rescale_1_0
s_branch L_rs_sa4_1_ret
L_rs_sa4_2:
s_call_b64 s[52:53], L_rescale_2_0
s_branch L_rs_sa4_2_ret
L_rs_s0_0:
s_call_b64 s[52:53], L_rescale_0_0
s_branch L_rs_s0_0_ret
L_rs_s0_1:
s_call_b64 s[52:53], L_rescale_1_0
s_branch L_rs_s0_1_ret
L_rs_s0_2:
s_call_b64 s[52:53], L_rescale_2_0
s_branch L_rs_s0_2_ret
L_rs_s1_0:
s_call_b64 s[52:53], L_rescale_0_1
s_branch L_rs_s1_0_ret
L_rs_s1_1:
s_call_b64 s[52:53], L_rescale_1_1
s_branch L_rs_s1_1_ret
L_rs_s1_2:
s_call_b64 s[52:53], L_rescale_2_1
s_branch L_rs_s1_2_ret
L_rs_s2_0:
s_call_b64 s[52:53], L_rescale_0_0
s_branch L_rs_s2_0_ret
L_rs_s2_1:
s_call_b64 s[52:53], L_rescale_1_0
s_branch L_rs_s2_1_ret
L_rs_s2_2:
s_call_b64 s[52:53], L_rescale_2_0
s_branch L_rs_s2_2_ret
L_rs_s3_0:
s_call_b64 s[52:53], L_rescale_0_1
s_branch L_rs_s3_0_ret
L_rs_s3_1:
s_call_b64 s[52:53], L_rescale_1_1
s_branch L_rs_s3_1_ret
L_rs_s3_2:
s_call_b64 s[52:53], L_rescale_2_1
s_branch L_rs_s3_2_ret
L_rs_s4_0:
s_call_b64 s[52:53], L_rescale_0_0
s_branch L_rs_s4_0_ret
L_rs_s4_1:
s_call_b64 s[52:53], L_rescale_1_0
s_branch L_rs_s4_1_ret
L_rs_s4_2:
s_call_b64 s[52:53], L_rescale_2_0
s_branch L_rs_s4_2_ret
L_rs_s5_0:
s_call_b64 s[52:53], L_rescale_0_1
s_branch L_rs_s5_0_ret
L_rs_s5_1:
s_call_b64 s[52:53], L_rescale_1_1
s_branch L_rs_s5_1_ret
L_rs_s5_2:
s_call_b64 s[52:53], L_rescale_2_1
s_branch L_rs_s5_2_ret
L_rs_s6_0:
s_call_b64 s[52:53], L_rescale_0_0
s_branch L_rs_s6_0_ret
L_rs_s6_1:
s_call_b64 s[52:53], L_rescale_1_0
s_branch L_rs_s6_1_ret
L_rs_s6_2:
s_call_b64 s[52:53], L_rescale_2_0
s_branch L_rs_s6_2_ret
L_rs_s7_0:
s_call_b64 s[52:53], L_rescale_0_1
s_branch L_rs_s7_0_ret
L_rs_s7_1:
s_call_b64 s[52:53], L_rescale_1_1
s_branch L_rs_s7_1_ret
L_rs_s7_2:
s_call_b64 s[52:53], L_rescale_2_1
s_branch L_rs_s7_2_ret
L_rs_s8_0:
s_call_b64 s[52:53], L_rescale_0_0
s_branch L_rs_s8_0_ret
L_rs_s8_1:
s_call_b64 s[52:53], L_rescale_1_0
s_branch L_rs_s8_1_ret
L_rs_s8_2:
s_call_b64 s[52:53], L_rescale_2_0
s_branch L_rs_s8_2_ret
L_rs_s9_0:
s_call_b64 s[52:53], L_rescale_0_1
s_branch L_rs_s9_0_ret
L_rs_s9_1:
s_call_b64 s[52:53], L_rescale_1_1
s_branch L_rs_s9_1_ret
L_rs_s9_2:
s_call_b64 s[52:53], L_rescale_2_1
s_branch L_rs_s9_2_ret
L_rs_s10_0:
s_call_b64 s[52:53], L_rescale_0_0
s_branch L_rs_s10_0_ret
L_rs_s10_1:
s_call_b64 s[52:53], L_rescale_1_0
s_branch L_rs_s10_1_ret
L_rs_s10_2:
s_call_b64 s[52:53], L_rescale_2_0
s_branch L_rs_s10_2_ret
L_rs_s11_0:
s_call_b64 s[52:53], L_rescale_0_1
s_branch L_rs_s11_0_ret
L_rs_s11_1:
s_call_b64 s[52:53], L_rescale_1_1
s_branch L_rs_s11_1_ret
L_rs_s11_2:
s_call_b64 s[52:53], L_rescale_2_1
s_branch L_rs_s11_2_ret
L_rs_s12_0:
s_call_b64 s[52:53], L_rescale_0_0
s_branch L_rs_s12_0_ret
L_rs_s12_1:
s_call_b64 s[52:53], L_rescale_1_0
s_branch L_rs_s12_1_ret
L_rs_s12_2:
s_call_b64 s[52:53], L_rescale_2_0
s_branch L_rs_s12_2_ret
L_rs_l_0:
s_call_b64 s[52:53], L_rescale_0_1
s_branch L_rs_l_0_ret
L_rs_l_1:
s_call_b64 s[52:53], L_rescale_1_1
s_branch L_rs_l_1_ret
L_rs_l_2:
s_call_b64 s[52:53], L_rescale_2_1
s_branch L_rs_l_2_ret
L_rescale_0_0:
s_mov_b32 s50, 1
s_nop 7
v_mfma_f32_16x16x32_bf16 v[176:179], a[68:71], v[144:147], v[176:179]
v_max3_f32 v230, v96, v97, v98
v_max3_f32 v230, v230, v99, v100
v_max3_f32 v230, v230, v101, v102
v_max_f32 v230, v230, v103
v_mov_b32 v231, v230
s_nop 1
v_permlane16_swap_b32 v230, v231
v_max_f32 v230, v230, v231
v_mov_b32 v231, v230
s_nop 1
v_permlane32_swap_b32 v230, v231
v_max_f32 v230, v230, v231
v_add_f32 v230, s56, v230
v_max_f32 v231, 0x00800000, v176
v_log_f32 v231, v231
s_nop 0
v_add_f32 v231, 0x41000000, v231
v_max3_f32 v230, v230, v231, 0
v_exp_f32 v231, -v230
v_sub_f32 v96, v96, v230
v_sub_f32 v120, v120, v230
v_sub_f32 v97, v97, v230
v_sub_f32 v121, v121, v230
v_sub_f32 v98, v98, v230
v_sub_f32 v122, v122, v230
v_sub_f32 v99, v99, v230
v_sub_f32 v123, v123, v230
v_sub_f32 v100, v100, v230
v_sub_f32 v124, v124, v230
v_sub_f32 v101, v101, v230
v_sub_f32 v125, v125, v230
v_sub_f32 v102, v102, v230
v_sub_f32 v126, v126, v230
v_sub_f32 v103, v103, v230
v_sub_f32 v127, v127, v230
v_sub_f32 v156, v156, v230
v_sub_f32 v157, v157, v230
v_sub_f32 v158, v158, v230
v_sub_f32 v159, v159, v230
v_max_f32 v176, 0, v176
v_mul_f32 v176, v176, v231
v_max_f32 v177, 0, v177
v_mul_f32 v177, v177, v231
v_max_f32 v178, 0, v178
v_mul_f32 v178, v178, v231
v_max_f32 v179, 0, v179
v_mul_f32 v179, v179, v231
v_mul_f32 v0, v0, v231
v_mul_f32 v1, v1, v231
v_mul_f32 v2, v2, v231
v_mul_f32 v3, v3, v231
v_mul_f32 v12, v12, v231
v_mul_f32 v13, v13, v231
v_mul_f32 v14, v14, v231
v_mul_f32 v15, v15, v231
v_mul_f32 v24, v24, v231
v_mul_f32 v25, v25, v231
v_mul_f32 v26, v26, v231
v_mul_f32 v27, v27, v231
v_mul_f32 v36, v36, v231
v_mul_f32 v37, v37, v231
v_mul_f32 v38, v38, v231
v_mul_f32 v39, v39, v231
v_mul_f32 v48, v48, v231
v_mul_f32 v49, v49, v231
v_mul_f32 v50, v50, v231
v_mul_f32 v51, v51, v231
v_mul_f32 v60, v60, v231
v_mul_f32 v61, v61, v231
v_mul_f32 v62, v62, v231
v_mul_f32 v63, v63, v231
v_mul_f32 v72, v72, v231
v_mul_f32 v73, v73, v231
v_mul_f32 v74, v74, v231
v_mul_f32 v75, v75, v231
v_mul_f32 v84, v84, v231
v_mul_f32 v85, v85, v231
v_mul_f32 v86, v86, v231
v_mul_f32 v87, v87, v231
v_exp_f32 v232, v96 clamp
v_exp_f32 v233, v97 clamp
v_exp_f32 v234, v98 clamp
v_exp_f32 v235, v99 clamp
v_exp_f32 v236, v100 clamp
v_exp_f32 v237, v101 clamp
v_exp_f32 v238, v102 clamp
v_exp_f32 v239, v103 clamp
v_cvt_pk_bf16_f32 v144, v232, v233
v_cvt_pk_bf16_f32 v145, v234, v235
v_cvt_pk_bf16_f32 v146, v236, v237
v_cvt_pk_bf16_f32 v147, v238, v239
s_nop 1
v_mfma_f32_16x16x32_bf16 v[176:179], a[64:67], v[144:147], v[176:179]
s_nop 7
s_setpc_b64 s[52:53]
L_rescale_0_1:
s_mov_b32 s50, 1
s_nop 7
v_mfma_f32_16x16x32_bf16 v[176:179], a[68:71], v[144:147], v[176:179]
v_max3_f32 v230, v120, v121, v122
v_max3_f32 v230, v230, v123, v124
v_max3_f32 v230, v230, v125, v126
v_max_f32 v230, v230, v127
v_mov_b32 v231, v230
s_nop 1
v_permlane16_swap_b32 v230, v231
v_max_f32 v230, v230, v231
v_mov_b32 v231, v230
s_nop 1
v_permlane32_swap_b32 v230, v231
v_max_f32 v230, v230, v231
v_add_f32 v230, s56, v230
v_max_f32 v231, 0x00800000, v176
v_log_f32 v231, v231
s_nop 0
v_add_f32 v231, 0x41000000, v231
v_max3_f32 v230, v230, v231, 0
v_exp_f32 v231, -v230
v_sub_f32 v120, v120, v230
v_sub_f32 v96, v96, v230
v_sub_f32 v121, v121, v230
v_sub_f32 v97, v97, v230
v_sub_f32 v122, v122, v230
v_sub_f32 v98, v98, v230
v_sub_f32 v123, v123, v230
v_sub_f32 v99, v99, v230
v_sub_f32 v124, v124, v230
v_sub_f32 v100, v100, v230
v_sub_f32 v125, v125, v230
v_sub_f32 v101, v101, v230
v_sub_f32 v126, v126, v230
v_sub_f32 v102, v102, v230
v_sub_f32 v127, v127, v230
v_sub_f32 v103, v103, v230
v_sub_f32 v156, v156, v230
v_sub_f32 v157, v157, v230
v_sub_f32 v158, v158, v230
v_sub_f32 v159, v159, v230
v_max_f32 v176, 0, v176
v_mul_f32 v176, v176, v231
v_max_f32 v177, 0, v177
v_mul_f32 v177, v177, v231
v_max_f32 v178, 0, v178
v_mul_f32 v178, v178, v231
v_max_f32 v179, 0, v179
v_mul_f32 v179, v179, v231
v_mul_f32 v0, v0, v231
v_mul_f32 v1, v1, v231
v_mul_f32 v2, v2, v231
v_mul_f32 v3, v3, v231
v_mul_f32 v12, v12, v231
v_mul_f32 v13, v13, v231
v_mul_f32 v14, v14, v231
v_mul_f32 v15, v15, v231
v_mul_f32 v24, v24, v231
v_mul_f32 v25, v25, v231
v_mul_f32 v26, v26, v231
v_mul_f32 v27, v27, v231
v_mul_f32 v36, v36, v231
v_mul_f32 v37, v37, v231
v_mul_f32 v38, v38, v231
v_mul_f32 v39, v39, v231
v_mul_f32 v48, v48, v231
v_mul_f32 v49, v49, v231
v_mul_f32 v50, v50, v231
v_mul_f32 v51, v51, v231
v_mul_f32 v60, v60, v231
v_mul_f32 v61, v61, v231
v_mul_f32 v62, v62, v231
v_mul_f32 v63, v63, v231
v_mul_f32 v72, v72, v231
v_mul_f32 v73, v73, v231
v_mul_f32 v74, v74, v231
v_mul_f32 v75, v75, v231
v_mul_f32 v84, v84, v231
v_mul_f32 v85, v85, v231
v_mul_f32 v86, v86, v231
v_mul_f32 v87, v87, v231
v_exp_f32 v232, v120 clamp
v_exp_f32 v233, v121 clamp
v_exp_f32 v234, v122 clamp
v_exp_f32 v235, v123 clamp
v_exp_f32 v236, v124 clamp
v_exp_f32 v237, v125 clamp
v_exp_f32 v238, v126 clamp
v_exp_f32 v239, v127 clamp
v_cvt_pk_bf16_f32 v144, v232, v233
v_cvt_pk_bf16_f32 v145, v234, v235
v_cvt_pk_bf16_f32 v146, v236, v237
v_cvt_pk_bf16_f32 v147, v238, v239
s_nop 1
v_mfma_f32_16x16x32_bf16 v[176:179], a[64:67], v[144:147], v[176:179]
s_nop 7
s_setpc_b64 s[52:53]
L_rescale_1_0:
s_mov_b32 s50, 1
s_nop 7
v_mfma_f32_16x16x32_bf16 v[180:183], a[68:71], v[148:151], v[180:183]
v_max3_f32 v230, v104, v105, v106
v_max3_f32 v230, v230, v107, v108
v_max3_f32 v230, v230, v109, v110
v_max_f32 v230, v230, v111
v_mov_b32 v231, v230
s_nop 1
v_permlane16_swap_b32 v230, v231
v_max_f32 v230, v230, v231
v_mov_b32 v231, v230
s_nop 1
v_permlane32_swap_b32 v230, v231
v_max_f32 v230, v230, v231
v_add_f32 v230, s56, v230
v_max_f32 v231, 0x00800000, v180
v_log_f32 v231, v231
s_nop 0
v_add_f32 v231, 0x41000000, v231
v_max3_f32 v230, v230, v231, 0
v_exp_f32 v231, -v230
v_sub_f32 v104, v104, v230
v_sub_f32 v128, v128, v230
v_sub_f32 v105, v105, v230
v_sub_f32 v129, v129, v230
v_sub_f32 v106, v106, v230
v_sub_f32 v130, v130, v230
v_sub_f32 v107, v107, v230
v_sub_f32 v131, v131, v230
v_sub_f32 v108, v108, v230
v_sub_f32 v132, v132, v230
v_sub_f32 v109, v109, v230
v_sub_f32 v133, v133, v230
v_sub_f32 v110, v110, v230
v_sub_f32 v134, v134, v230
v_sub_f32 v111, v111, v230
v_sub_f32 v135, v135, v230
v_sub_f32 v160, v160, v230
v_sub_f32 v161, v161, v230
v_sub_f32 v162, v162, v230
v_sub_f32 v163, v163, v230
v_max_f32 v180, 0, v180
v_mul_f32 v180, v180, v231
v_max_f32 v181, 0, v181
v_mul_f32 v181, v181, v231
v_max_f32 v182, 0, v182
v_mul_f32 v182, v182, v231
v_max_f32 v183, 0, v183
v_mul_f32 v183, v183, v231
v_mul_f32 v4, v4, v231
v_mul_f32 v5, v5, v231
v_mul_f32 v6, v6, v231
v_mul_f32 v7, v7, v231
v_mul_f32 v16, v16, v231
v_mul_f32 v17, v17, v231
v_mul_f32 v18, v18, v231
v_mul_f32 v19, v19, v231
v_mul_f32 v28, v28, v231
v_mul_f32 v29, v29, v231
v_mul_f32 v30, v30, v231
v_mul_f32 v31, v31, v231
v_mul_f32 v40, v40, v231
v_mul_f32 v41, v41, v231
v_mul_f32 v42, v42, v231
v_mul_f32 v43, v43, v231
v_mul_f32 v52, v52, v231
v_mul_f32 v53, v53, v231
v_mul_f32 v54, v54, v231
v_mul_f32 v55, v55, v231
v_mul_f32 v64, v64, v231
v_mul_f32 v65, v65, v231
v_mul_f32 v66, v66, v231
v_mul_f32 v67, v67, v231
v_mul_f32 v76, v76, v231
v_mul_f32 v77, v77, v231
v_mul_f32 v78, v78, v231
v_mul_f32 v79, v79, v231
v_mul_f32 v88, v88, v231
v_mul_f32 v89, v89, v231
v_mul_f32 v90, v90, v231
v_mul_f32 v91, v91, v231
v_exp_f32 v232, v104 clamp
v_exp_f32 v233, v105 clamp
v_exp_f32 v234, v106 clamp
v_exp_f32 v235, v107 clamp
v_exp_f32 v236, v108 clamp
v_exp_f32 v237, v109 clamp
v_exp_f32 v238, v110 clamp
v_exp_f32 v239, v111 clamp
v_cvt_pk_bf16_f32 v148, v232, v233
v_cvt_pk_bf16_f32 v149, v234, v235
v_cvt_pk_bf16_f32 v150, v236, v237
v_cvt_pk_bf16_f32 v151, v238, v239
s_nop 1
v_mfma_f32_16x16x32_bf16 v[180:183], a[64:67], v[148:151], v[180:183]
s_nop 7
s_setpc_b64 s[52:53]
L_rescale_1_1:
s_mov_b32 s50, 1
s_nop 7
v_mfma_f32_16x16x32_bf16 v[180:183], a[68:71], v[148:151], v[180:183]
v_max3_f32 v230, v128, v129, v130
v_max3_f32 v230, v230, v131, v132
v_max3_f32 v230, v230, v133, v134
v_max_f32 v230, v230, v135
v_mov_b32 v231, v230
s_nop 1
v_permlane16_swap_b32 v230, v231
v_max_f32 v230, v230, v231
v_mov_b32 v231, v230
s_nop 1
v_permlane32_swap_b32 v230, v231
v_max_f32 v230, v230, v231
v_add_f32 v230, s56, v230
v_max_f32 v231, 0x00800000, v180
v_log_f32 v231, v231
s_nop 0
v_add_f32 v231, 0x41000000, v231
v_max3_f32 v230, v230, v231, 0
v_exp_f32 v231, -v230
v_sub_f32 v128, v128, v230
v_sub_f32 v104, v104, v230
v_sub_f32 v129, v129, v230
v_sub_f32 v105, v105, v230
v_sub_f32 v130, v130, v230
v_sub_f32 v106, v106, v230
v_sub_f32 v131, v131, v230
v_sub_f32 v107, v107, v230
v_sub_f32 v132, v132, v230
v_sub_f32 v108, v108, v230
v_sub_f32 v133, v133, v230
v_sub_f32 v109, v109, v230
v_sub_f32 v134, v134, v230
v_sub_f32 v110, v110, v230
v_sub_f32 v135, v135, v230
v_sub_f32 v111, v111, v230
v_sub_f32 v160, v160, v230
v_sub_f32 v161, v161, v230
v_sub_f32 v162, v162, v230
v_sub_f32 v163, v163, v230
v_max_f32 v180, 0, v180
v_mul_f32 v180, v180, v231
v_max_f32 v181, 0, v181
v_mul_f32 v181, v181, v231
v_max_f32 v182, 0, v182
v_mul_f32 v182, v182, v231
v_max_f32 v183, 0, v183
v_mul_f32 v183, v183, v231
v_mul_f32 v4, v4, v231
v_mul_f32 v5, v5, v231
v_mul_f32 v6, v6, v231
v_mul_f32 v7, v7, v231
v_mul_f32 v16, v16, v231
v_mul_f32 v17, v17, v231
v_mul_f32 v18, v18, v231
v_mul_f32 v19, v19, v231
v_mul_f32 v28, v28, v231
v_mul_f32 v29, v29, v231
v_mul_f32 v30, v30, v231
v_mul_f32 v31, v31, v231
v_mul_f32 v40, v40, v231
v_mul_f32 v41, v41, v231
v_mul_f32 v42, v42, v231
v_mul_f32 v43, v43, v231
v_mul_f32 v52, v52, v231
v_mul_f32 v53, v53, v231
v_mul_f32 v54, v54, v231
v_mul_f32 v55, v55, v231
v_mul_f32 v64, v64, v231
v_mul_f32 v65, v65, v231
v_mul_f32 v66, v66, v231
v_mul_f32 v67, v67, v231
v_mul_f32 v76, v76, v231
v_mul_f32 v77, v77, v231
v_mul_f32 v78, v78, v231
v_mul_f32 v79, v79, v231
v_mul_f32 v88, v88, v231
v_mul_f32 v89, v89, v231
v_mul_f32 v90, v90, v231
v_mul_f32 v91, v91, v231
v_exp_f32 v232, v128 clamp
v_exp_f32 v233, v129 clamp
v_exp_f32 v234, v130 clamp
v_exp_f32 v235, v131 clamp
v_exp_f32 v236, v132 clamp
v_exp_f32 v237, v133 clamp
v_exp_f32 v238, v134 clamp
v_exp_f32 v239, v135 clamp
v_cvt_pk_bf16_f32 v148, v232, v233
v_cvt_pk_bf16_f32 v149, v234, v235
v_cvt_pk_bf16_f32 v150, v236, v237
v_cvt_pk_bf16_f32 v151, v238, v239
s_nop 1
v_mfma_f32_16x16x32_bf16 v[180:183], a[64:67], v[148:151], v[180:183]
s_nop 7
s_setpc_b64 s[52:53]
L_rescale_2_0:
s_mov_b32 s50, 1
s_nop 7
v_mfma_f32_16x16x32_bf16 v[184:187], a[68:71], v[152:155], v[184:187]
v_max3_f32 v230, v112, v113, v114
v_max3_f32 v230, v230, v115, v116
v_max3_f32 v230, v230, v117, v118
v_max_f32 v230, v230, v119
v_mov_b32 v231, v230
s_nop 1
v_permlane16_swap_b32 v230, v231
v_max_f32 v230, v230, v231
v_mov_b32 v231, v230
s_nop 1
v_permlane32_swap_b32 v230, v231
v_max_f32 v230, v230, v231
v_add_f32 v230, s56, v230
v_max_f32 v231, 0x00800000, v184
v_log_f32 v231, v231
s_nop 0
v_add_f32 v231, 0x41000000, v231
v_max3_f32 v230, v230, v231, 0
v_exp_f32 v231, -v230
v_sub_f32 v112, v112, v230
v_sub_f32 v136, v136, v230
v_sub_f32 v113, v113, v230
v_sub_f32 v137, v137, v230
v_sub_f32 v114, v114, v230
v_sub_f32 v138, v138, v230
v_sub_f32 v115, v115, v230
v_sub_f32 v139, v139, v230
v_sub_f32 v116, v116, v230
v_sub_f32 v140, v140, v230
v_sub_f32 v117, v117, v230
v_sub_f32 v141, v141, v230
v_sub_f32 v118, v118, v230
v_sub_f32 v142, v142, v230
v_sub_f32 v119, v119, v230
v_sub_f32 v143, v143, v230
v_sub_f32 v164, v164, v230
v_sub_f32 v165, v165, v230
v_sub_f32 v166, v166, v230
v_sub_f32 v167, v167, v230
v_max_f32 v184, 0, v184
v_mul_f32 v184, v184, v231
v_max_f32 v185, 0, v185
v_mul_f32 v185, v185, v231
v_max_f32 v186, 0, v186
v_mul_f32 v186, v186, v231
v_max_f32 v187, 0, v187
v_mul_f32 v187, v187, v231
v_mul_f32 v8, v8, v231
v_mul_f32 v9, v9, v231
v_mul_f32 v10, v10, v231
v_mul_f32 v11, v11, v231
v_mul_f32 v20, v20, v231
v_mul_f32 v21, v21, v231
v_mul_f32 v22, v22, v231
v_mul_f32 v23, v23, v231
v_mul_f32 v32, v32, v231
v_mul_f32 v33, v33, v231
v_mul_f32 v34, v34, v231
v_mul_f32 v35, v35, v231
v_mul_f32 v44, v44, v231
v_mul_f32 v45, v45, v231
v_mul_f32 v46, v46, v231
v_mul_f32 v47, v47, v231
v_mul_f32 v56, v56, v231
v_mul_f32 v57, v57, v231
v_mul_f32 v58, v58, v231
v_mul_f32 v59, v59, v231
v_mul_f32 v68, v68, v231
v_mul_f32 v69, v69, v231
v_mul_f32 v70, v70, v231
v_mul_f32 v71, v71, v231
v_mul_f32 v80, v80, v231
v_mul_f32 v81, v81, v231
v_mul_f32 v82, v82, v231
v_mul_f32 v83, v83, v231
v_mul_f32 v92, v92, v231
v_mul_f32 v93, v93, v231
v_mul_f32 v94, v94, v231
v_mul_f32 v95, v95, v231
v_exp_f32 v232, v112 clamp
v_exp_f32 v233, v113 clamp
v_exp_f32 v234, v114 clamp
v_exp_f32 v235, v115 clamp
v_exp_f32 v236, v116 clamp
v_exp_f32 v237, v117 clamp
v_exp_f32 v238, v118 clamp
v_exp_f32 v239, v119 clamp
v_cvt_pk_bf16_f32 v152, v232, v233
v_cvt_pk_bf16_f32 v153, v234, v235
v_cvt_pk_bf16_f32 v154, v236, v237
v_cvt_pk_bf16_f32 v155, v238, v239
s_nop 1
v_mfma_f32_16x16x32_bf16 v[184:187], a[64:67], v[152:155], v[184:187]
s_nop 7
s_setpc_b64 s[52:53]
L_rescale_2_1:
s_mov_b32 s50, 1
s_nop 7
v_mfma_f32_16x16x32_bf16 v[184:187], a[68:71], v[152:155], v[184:187]
v_max3_f32 v230, v136, v137, v138
v_max3_f32 v230, v230, v139, v140
v_max3_f32 v230, v230, v141, v142
v_max_f32 v230, v230, v143
v_mov_b32 v231, v230
s_nop 1
v_permlane16_swap_b32 v230, v231
v_max_f32 v230, v230, v231
v_mov_b32 v231, v230
s_nop 1
v_permlane32_swap_b32 v230, v231
v_max_f32 v230, v230, v231
v_add_f32 v230, s56, v230
v_max_f32 v231, 0x00800000, v184
v_log_f32 v231, v231
s_nop 0
v_add_f32 v231, 0x41000000, v231
v_max3_f32 v230, v230, v231, 0
v_exp_f32 v231, -v230
v_sub_f32 v136, v136, v230
v_sub_f32 v112, v112, v230
v_sub_f32 v137, v137, v230
v_sub_f32 v113, v113, v230
v_sub_f32 v138, v138, v230
v_sub_f32 v114, v114, v230
v_sub_f32 v139, v139, v230
v_sub_f32 v115, v115, v230
v_sub_f32 v140, v140, v230
v_sub_f32 v116, v116, v230
v_sub_f32 v141, v141, v230
v_sub_f32 v117, v117, v230
v_sub_f32 v142, v142, v230
v_sub_f32 v118, v118, v230
v_sub_f32 v143, v143, v230
v_sub_f32 v119, v119, v230
v_sub_f32 v164, v164, v230
v_sub_f32 v165, v165, v230
v_sub_f32 v166, v166, v230
v_sub_f32 v167, v167, v230
v_max_f32 v184, 0, v184
v_mul_f32 v184, v184, v231
v_max_f32 v185, 0, v185
v_mul_f32 v185, v185, v231
v_max_f32 v186, 0, v186
v_mul_f32 v186, v186, v231
v_max_f32 v187, 0, v187
v_mul_f32 v187, v187, v231
v_mul_f32 v8, v8, v231
v_mul_f32 v9, v9, v231
v_mul_f32 v10, v10, v231
v_mul_f32 v11, v11, v231
v_mul_f32 v20, v20, v231
v_mul_f32 v21, v21, v231
v_mul_f32 v22, v22, v231
v_mul_f32 v23, v23, v231
v_mul_f32 v32, v32, v231
v_mul_f32 v33, v33, v231
v_mul_f32 v34, v34, v231
v_mul_f32 v35, v35, v231
v_mul_f32 v44, v44, v231
v_mul_f32 v45, v45, v231
v_mul_f32 v46, v46, v231
v_mul_f32 v47, v47, v231
v_mul_f32 v56, v56, v231
v_mul_f32 v57, v57, v231
v_mul_f32 v58, v58, v231
v_mul_f32 v59, v59, v231
v_mul_f32 v68, v68, v231
v_mul_f32 v69, v69, v231
v_mul_f32 v70, v70, v231
v_mul_f32 v71, v71, v231
v_mul_f32 v80, v80, v231
v_mul_f32 v81, v81, v231
v_mul_f32 v82, v82, v231
v_mul_f32 v83, v83, v231
v_mul_f32 v92, v92, v231
v_mul_f32 v93, v93, v231
v_mul_f32 v94, v94, v231
v_mul_f32 v95, v95, v231
v_exp_f32 v232, v136 clamp
v_exp_f32 v233, v137 clamp
v_exp_f32 v234, v138 clamp
v_exp_f32 v235, v139 clamp
v_exp_f32 v236, v140 clamp
v_exp_f32 v237, v141 clamp
v_exp_f32 v238, v142 clamp
v_exp_f32 v239, v143 clamp
v_cvt_pk_bf16_f32 v152, v232, v233
v_cvt_pk_bf16_f32 v153, v234, v235
v_cvt_pk_bf16_f32 v154, v236, v237
v_cvt_pk_bf16_f32 v155, v238, v239
s_nop 1
v_mfma_f32_16x16x32_bf16 v[184:187], a[64:67], v[152:155], v[184:187]
s_nop 7
s_setpc_b64 s[52:53]
.section .rodata,"a"
.p2align 6
.amdhsa_kernel standalone__gqa_softmax__near_ridge_kernel
  .amdhsa_next_free_vgpr 416
  .amdhsa_next_free_sgpr 96
  .amdhsa_accum_offset 256
  .amdhsa_group_segment_fixed_size 0
  .amdhsa_kernarg_size 48
  .amdhsa_user_sgpr_count 2
  .amdhsa_user_sgpr_kernarg_segment_ptr 1
  .amdhsa_system_sgpr_workgroup_id_x 1
  .amdhsa_dx10_clamp 0
.end_amdhsa_kernel
```
